```python
import torch

def _softmax(x, axis=-1):
    return torch.softmax(x, dim=axis)
def _gelu(x):
    return torch.nn.functional.gelu(x, approximate="tanh")
def _silu(x):
    return torch.nn.functional.silu(x)
def _sigmoid(x):
    return torch.sigmoid(x)
def _layernorm(x, axis=-1, eps=1e-5):
    m = x.mean(dim=axis, keepdim=True)
    v = x.var(dim=axis, keepdim=True, unbiased=False)
    return (x - m) / torch.sqrt(v + eps)
def _scatter_add(tgt, idx, src, axis=0):
    return tgt.clone().index_add_(axis, idx, src)
def _segment_sum(src, seg, n):
    out = torch.zeros((n,) + src.shape[1:], dtype=src.dtype)
    return out.index_add_(0, seg, src)
def _pad(x, pw):
    flat = tuple(v for pair in reversed(pw) for v in pair)
    return torch.nn.functional.pad(x, flat)

kernel_name = 'standalone__cheap_equivariant_egnn__graph'

def setup_inputs():

    _w = (lambda a: (lambda t: t.to(torch.bfloat16) if t.is_floating_point() else t)(torch.as_tensor(a)))
    N, deg, D, De = 10000, 64, 64, max(0, 1)
    E = N * deg
    return {
        "h": _w((lambda *s: torch.randn(*s, dtype=torch.bfloat16) * 0.1)(N, D)),
        "pos": _w((lambda *s: torch.randn(*s, dtype=torch.bfloat16) * 0.8)(N, 3)),
        "e_attr": _w((lambda *s: torch.randn(*s, dtype=torch.bfloat16) * 0.8)(E, De)),
        "src": _w((lambda lo, hi, *s: torch.randint(lo, hi, s))(0, N, E).to(torch.int64)),
        "dst": _w((lambda lo, hi, *s: torch.randint(lo, hi, s))(0, N, E).to(torch.int64)),
        "w_e": _w(0.1 * (lambda *s: torch.randn(*s, dtype=torch.bfloat16) * 0.8)(2 * D + 1 + De, D)),
        "w_x": _w(0.1 * (lambda *s: torch.randn(*s, dtype=torch.bfloat16) * 0.1)(D, 1)),
        "w_h": _w(0.1 * (lambda *s: torch.randn(*s, dtype=torch.bfloat16) * 0.1)(2 * D, D)),
    }

def reference(h, pos, e_attr, src, dst, w_e, w_x, w_h):
    N, D = h.shape[0], h.shape[1]
    diff = pos[dst] - pos[src]
    dist2 = torch.sum(diff * diff, axis=-1, keepdims=True)
    e_in = torch.concatenate([h[dst], h[src], dist2, e_attr], axis=-1)
    m_ij = _silu(e_in @ w_e)
    coord_scale = m_ij @ w_x
    pos_new = pos + _segment_sum(diff * coord_scale, dst, N)
    m_i = _segment_sum(m_ij, dst, N)
    h_new = h + _silu(torch.concatenate([h, m_i], axis=-1) @ w_h)
    return h_new, pos_new
```

```asm
; @launch grid=(256,1,1) block=(512,1,1) lds=163840
.amdgcn_target "amdgcn-amd-amdhsa--gfx950"
.text
.globl standalone__cheap_equivariant_egnn__graph_kernel
.p2align 8
.type standalone__cheap_equivariant_egnn__graph_kernel,@function
standalone__cheap_equivariant_egnn__graph_kernel:
    s_cmp_ge_u32 s2, 256
    s_cbranch_scc1 L_end
    s_load_dwordx16 s[4:19], s[0:1], 0
    s_load_dwordx4 s[20:23], s[0:1], 64
    s_load_dwordx2 s[24:25], s[0:1], 80
    s_getpc_b64 s[62:63]
L_pc:
    v_lshlrev_b32 v5, 5, v0
    v_min_u32 v5, L_end-L_pc, v5
    s_mov_b32 exec_lo, 0x11111111
    s_mov_b32 exec_hi, 0x11111111
    global_load_dword v70, v5, s[62:63]
    s_mov_b64 exec, -1
    s_mul_i32 s3, s2, 10000
    v_lshl_add_u32 v8, v0, 4, s3
    s_add_u32 s60, s3, 8192
    v_min_u32 v6, 451, v0
    v_lshl_add_u32 v9, v6, 2, s60
    s_lshr_b32 s3, s3, 1
    v_lshl_add_u32 v10, v0, 3, s3
    s_add_u32 s60, s3, 4096
    v_lshl_add_u32 v11, v6, 1, s60
    v_lshrrev_b32 v5, 6, v0
    v_and_b32 v254, 63, v0
    v_readfirstlane_b32 s26, v5
    v_mov_b32 v216, 0
    v_mov_b32 v217, 0
    v_lshlrev_b32 v12, 4, v0
    v_lshlrev_b32 v5, 3, v0
    ds_write_b64 v5, v[216:217]
    s_and_b32 s60, s2, 7
    s_lshl_b32 s27, s60, 5
    s_lshr_b32 s96, s2, 3
    s_add_u32 s27, s27, s96
    s_mul_i32 s60, s27, 625
    s_add_u32 s45, s60, 15
    s_add_u32 s55, s60, 640
    s_lshr_b32 s45, s45, 4
    s_lshr_b32 s55, s55, 4
    s_sub_u32 s55, s55, s45
    v_and_b32 v5, 16, v254
    v_and_b32 v6, 64, v0
    v_lshl_or_b32 v5, v5, 1, v6
    v_xor_b32 v64, v5, v12
    v_add_u32 v65, 8192, v64
    v_lshlrev_b32 v5, 1, v254
    s_lshl_b32 s60, s45, 7
    v_and_b32 v5, 0x70, v5
    v_xad_u32 v67, v5, v12, s60
    s_lshl_b32 s60, s26, 10
    s_add_u32 m0, s60, 132224
    s_waitcnt lgkmcnt(0)
    global_load_dwordx4 v[16:19], v8, s[12:13]
    global_load_dword v20, v9, s[12:13]
    s_load_dword s40, s[24:25], 0
    s_mov_b32 s36, s4
    s_and_b32 s37, s5, 0xffff
    s_add_u32 s38, s45, 40
    s_min_u32 s38, s38, 10000
    s_lshl_b32 s38, s38, 7
    s_mov_b32 s39, 0x20000
    s_cmp_ge_u32 s26, 6
    s_barrier
    global_load_lds_dwordx4 v65, s[14:15]
    s_cbranch_scc1 L_d67
    s_add_u32 m0, s60, 156800
    s_nop 0
    buffer_load_dwordx4 v67, s[36:39], 0 offen lds
    s_branch L_ddone
L_d67:
    s_add_u32 s62, s14, 16384
    s_addc_u32 s63, s15, 0
    v_lshlrev_b32 v5, 4, v254
    s_cmp_eq_u32 s26, 7
    s_cselect_b64 s[62:63], s[16:17], s[62:63]
    s_cselect_b32 s61, 256, 0
    s_cselect_b32 s97, 8, 16
    s_add_u32 m0, s61, 62208
    s_bfm_b64 exec, s97, 0
    global_load_lds_dwordx4 v5, s[62:63]
    s_mov_b64 exec, -1
L_ddone:
    s_barrier
    global_load_dwordx4 v[24:27], v8, s[10:11]
    global_load_dword v28, v9, s[10:11]
    global_load_dwordx2 v[32:33], v10, s[8:9]
    global_load_short_d16_hi v34, v11, s[8:9]
    v_mov_b64 v[156:157], 0
    v_mov_b64 v[158:159], 0
    ds_write_b128 v216, v[156:159] offset:21520
    s_mov_b32 s32, s6
    s_and_b32 s33, s7, 0xffff
    s_mov_b32 s34, 60000
    s_mov_b32 s35, 0x20000
    s_mul_i32 s47, s26, 86
    s_lshr_b32 s47, s47, 8
    s_mul_i32 s61, s47, 3
    s_sub_u32 s46, s26, s61
    s_and_b32 s61, s26, 2
    s_lshl_b32 s61, s61, 2
    s_and_b32 s62, s26, 1
    s_add_u32 s61, s61, s62
    s_lshr_b32 s62, s26, 2
    s_lshl_b32 s62, s62, 1
    s_add_u32 s61, s61, s62
    s_lshl_b32 s61, s61, 7
    s_add_u32 s61, s61, 8192
    v_and_b32 v5, 0x70, v64
    v_bfe_u32 v6, v254, 3, 2
    v_lshl_add_u32 v5, v6, 11, v5
    v_lshrrev_b32 v6, 5, v254
    v_lshl_add_u32 v5, v6, 9, v5
    v_add_u32 v66, s61, v5
    v_and_b32 v1, 15, v254
    v_lshrrev_b32 v3, 4, v254
    s_lshl_b32 s61, s46, 11
    s_add_u32 s61, s61, 156800
    v_and_b32 v2, 7, v254
    v_xor_b32 v2, v2, v3
    v_lshl_add_u32 v4, v1, 7, s61
    v_lshl_add_u32 v145, v2, 4, v4
    v_xor_b32 v146, 64, v145
    v_bfe_u32 v6, v254, 2, 2
    v_and_b32 v2, 3, v254
    v_lshl_add_u32 v4, v3, 3, v6
    v_lshlrev_b32 v7, 2, v254
    v_and_b32 v7, 0x60, v7
    s_xor_b32 s61, s47, 1
    s_lshl_b32 s61, s61, 13
    s_add_u32 s61, s61, 124032
    v_lshl_add_u32 v5, v4, 7, s61
    v_lshl_add_u32 v5, v2, 3, v5
    v_xor_b32 v148, v7, v5
    v_xor_b32 v149, 32, v148
    v_xor_b32 v150, 64, v148
    v_xor_b32 v151, 96, v148
    s_lshl_b32 s61, s47, 6
    s_add_u32 s61, s61, 140416
    v_lshl_add_u32 v6, v2, 4, s61
    v_lshl_add_u32 v5, v4, 7, v6
    v_xor_b32 v144, v7, v5
    s_lshl_b32 s61, s46, 4
    s_add_u32 s61, s61, s45
    s_lshl_b32 s61, s61, 7
    s_add_u32 s61, s61, 524288
    v_lshl_add_u32 v2, v3, 9, s61
    v_lshl_add_u32 v147, v1, 3, v2
    v_lshrrev_b32 v1, 5, v254
    v_and_b32 v7, 3, v254
    v_bfe_u32 v6, v254, 3, 2
    v_lshlrev_b32 v6, 2, v6
    v_lshl_add_u32 v7, v7, 4, v6
    v_bfe_u32 v6, v254, 2, 1
    v_add_u32 v7, v7, v6
    v_lshl_add_u32 v7, v1, 1, v7
    v_lshlrev_b32 v68, 1, v7
    v_mul_u32_u24 v196, 104, v7
    v_add_u32 v196, 55552, v196
    v_mov_b32 v13, 1
    s_mov_b32 s61, 429497
    s_mov_b32 s62, -2560000
    s_cmp_eq_u32 s26, 7
    s_cselect_b64 s[68:69], 15, -1
    v_lshlrev_b32 v1, 4, v254
    s_lshl_b32 s63, s2, 10
    s_add_u32 s63, s63, 65536
    v_add_u32 v69, s63, v1
    s_mul_i32 s63, s2, 13440
    s_lshl_b32 s97, s26, 12
    s_add_u32 s63, s63, s97
    s_add_u32 s63, s63, 2097152
    v_add_u32 v136, s63, v1
    v_add_u32 v138, s97, v1
    v_add_u32 v137, 8192, v138
    v_lshrrev_b32 v138, 2, v138
    v_mov_b32 v139, 0xfcfcfc
    s_cmp_eq_u32 s26, 3
    s_cselect_b64 s[64:65], 255, -1
    s_cselect_b64 s[66:67], 0, -1
    s_waitcnt vmcnt(6)
    v_mul_u32_u24 v48, s61, v16
    v_mul_u32_u24 v49, s61, v17
    v_mul_u32_u24 v50, s61, v18
    v_mul_u32_u24 v51, s61, v19
    v_mul_u32_u24 v52, s61, v20
    v_lshlrev_b32_sdwa v48, 2, v48 dst_sel:DWORD dst_unused:UNUSED_PAD src0_sel:DWORD src1_sel:BYTE_3
    ds_add_rtn_u32 v56, v48, v13 offset:0
    v_lshlrev_b32_sdwa v49, 2, v49 dst_sel:DWORD dst_unused:UNUSED_PAD src0_sel:DWORD src1_sel:BYTE_3
    ds_add_rtn_u32 v57, v49, v13 offset:0
    v_lshlrev_b32_sdwa v50, 2, v50 dst_sel:DWORD dst_unused:UNUSED_PAD src0_sel:DWORD src1_sel:BYTE_3
    ds_add_rtn_u32 v58, v50, v13 offset:0
    v_lshlrev_b32_sdwa v51, 2, v51 dst_sel:DWORD dst_unused:UNUSED_PAD src0_sel:DWORD src1_sel:BYTE_3
    ds_add_rtn_u32 v59, v51, v13 offset:0
    v_lshlrev_b32_sdwa v52, 2, v52 dst_sel:DWORD dst_unused:UNUSED_PAD src0_sel:DWORD src1_sel:BYTE_3
    s_mov_b64 exec, s[68:69]
    ds_add_rtn_u32 v60, v52, v13 offset:0
    s_mov_b64 exec, -1
    s_add_u32 m0, s60, 124032
    s_nop 0
    global_load_lds_dwordx4 v64, s[14:15]
    s_add_u32 m0, s60, 140416
    s_nop 0
    global_load_lds_dwordx4 v64, s[18:19]
    s_add_u32 m0, s60, 148608
    s_nop 0
    global_load_lds_dwordx4 v66, s[18:19]
    s_cmp_ge_u32 s26, 3
    ds_read_b32 v71, v216
    s_waitcnt vmcnt(7) lgkmcnt(1)
    s_barrier
    s_cbranch_scc1 L_nobp
    ds_read_b128 v[72:75], v145
    ds_read_b128 v[76:79], v146
    ds_read_b64_tr_b16 v[80:81], v148 offset:0
    ds_read_b64_tr_b16 v[82:83], v148 offset:512
    ds_read_b64_tr_b16 v[84:85], v148 offset:4096
    ds_read_b64_tr_b16 v[86:87], v148 offset:4608
    ds_read_b64_tr_b16 v[88:89], v149 offset:0
    ds_read_b64_tr_b16 v[90:91], v149 offset:512
    ds_read_b64_tr_b16 v[92:93], v149 offset:4096
    ds_read_b64_tr_b16 v[94:95], v149 offset:4608
    ds_read_b64_tr_b16 v[96:97], v150 offset:0
    ds_read_b64_tr_b16 v[98:99], v150 offset:512
    ds_read_b64_tr_b16 v[100:101], v150 offset:4096
    ds_read_b64_tr_b16 v[102:103], v150 offset:4608
    ds_read_b64_tr_b16 v[104:105], v151 offset:0
    ds_read_b64_tr_b16 v[106:107], v151 offset:512
    ds_read_b64_tr_b16 v[108:109], v151 offset:4096
    ds_read_b64_tr_b16 v[110:111], v151 offset:4608
    ds_read_b128 v[4:7], v1 offset:0
    ds_read_b32 v71, v216
    s_mov_b32 s96, 0xbfb8aa3b
    s_waitcnt lgkmcnt(14)
    v_mfma_f32_16x16x32_bf16 v[112:115], v[72:75], v[80:83], 0
    v_mfma_f32_16x16x32_bf16 v[112:115], v[76:79], v[84:87], v[112:115]
    s_waitcnt lgkmcnt(10)
    v_mfma_f32_16x16x32_bf16 v[116:119], v[72:75], v[88:91], 0
    v_mfma_f32_16x16x32_bf16 v[116:119], v[76:79], v[92:95], v[116:119]
    s_waitcnt lgkmcnt(6)
    v_mfma_f32_16x16x32_bf16 v[120:123], v[72:75], v[96:99], 0
    v_mfma_f32_16x16x32_bf16 v[120:123], v[76:79], v[100:103], v[120:123]
    s_waitcnt lgkmcnt(2)
    v_mfma_f32_16x16x32_bf16 v[124:127], v[72:75], v[104:107], 0
    v_mfma_f32_16x16x32_bf16 v[124:127], v[76:79], v[108:111], v[124:127]
    s_cmp_eq_u32 s46, 2
    s_cselect_b32 s63, 0, -1
    v_pk_mul_f32 v[112:113], v[112:113], s[96:97] op_sel_hi:[1,0]
    v_pk_mul_f32 v[114:115], v[114:115], s[96:97] op_sel_hi:[1,0]
    v_pk_mul_f32 v[116:117], v[116:117], s[96:97] op_sel_hi:[1,0]
    v_pk_mul_f32 v[118:119], v[118:119], s[96:97] op_sel_hi:[1,0]
    v_pk_mul_f32 v[120:121], v[120:121], s[96:97] op_sel_hi:[1,0]
    v_pk_mul_f32 v[122:123], v[122:123], s[96:97] op_sel_hi:[1,0]
    v_pk_mul_f32 v[124:125], v[124:125], s[96:97] op_sel_hi:[1,0]
    v_pk_mul_f32 v[126:127], v[126:127], s[96:97] op_sel_hi:[1,0]
    v_cvt_pk_bf16_f32 v80, v112, v116
    v_cvt_pk_bf16_f32 v81, v120, v124
    v_cvt_pk_bf16_f32 v82, v113, v117
    v_cvt_pk_bf16_f32 v83, v121, v125
    v_cvt_pk_bf16_f32 v84, v114, v118
    v_cvt_pk_bf16_f32 v85, v122, v126
    v_cvt_pk_bf16_f32 v86, v115, v119
    v_cvt_pk_bf16_f32 v87, v123, v127
    s_mov_b32 exec_hi, s63
    global_store_dwordx2 v147, v[80:81], s[24:25] offset:0 sc1
    global_store_dwordx2 v147, v[82:83], s[24:25] offset:128 sc1
    global_store_dwordx2 v147, v[84:85], s[24:25] offset:256 sc1
    global_store_dwordx2 v147, v[86:87], s[24:25] offset:384 sc1
    s_mov_b64 exec, -1
    s_branch L_bpdone
L_nobp:
    ds_read_b128 v[4:7], v1 offset:0
    ds_read_b32 v71, v216
L_bpdone:
    s_waitcnt lgkmcnt(1)
    v_add_u32 v5, v4, v5
    v_add_u32 v6, v5, v6
    v_add_u32 v7, v6, v7
    v_mov_b32 v3, v7
    v_lshlrev_b32 v36, 18, v16
    v_lshlrev_b32 v37, 18, v17
    v_add_u32_dpp v3, v3, v3 row_shr:1 row_mask:0xf bank_mask:0xf bound_ctrl:1
    v_lshlrev_b32 v38, 18, v18
    v_lshlrev_b32 v39, 18, v19
    v_add_u32_dpp v3, v3, v3 row_shr:2 row_mask:0xf bank_mask:0xf bound_ctrl:1
    v_lshlrev_b32 v40, 18, v20
    v_mad_i32_i24 v36, v48, s62, v36
    v_add_u32_dpp v3, v3, v3 row_shr:4 row_mask:0xf bank_mask:0xf bound_ctrl:1
    v_mad_i32_i24 v37, v49, s62, v37
    v_mad_i32_i24 v38, v50, s62, v38
    v_add_u32_dpp v3, v3, v3 row_shr:8 row_mask:0xf bank_mask:0xf bound_ctrl:1
    v_mad_i32_i24 v39, v51, s62, v39
    v_mad_i32_i24 v40, v52, s62, v40
    v_add_u32_dpp v3, v3, v3 row_bcast:15 row_mask:0xa bank_mask:0xf
    s_mov_b32 s63, 0xffff0000
    s_movk_i32 s61, 21846
    v_add_u32_dpp v3, v3, v3 row_bcast:31 row_mask:0xc bank_mask:0xf
    v_sub_u32 v8, v3, v7
    v_add_u32 v9, v8, v4
    v_add_u32 v10, v8, v5
    v_add_u32 v11, v8, v6
    ds_write_b128 v1, v[8:11] offset:1024
    ds_read_b32 v48, v48 offset:1024
    ds_read_b32 v49, v49 offset:1024
    ds_read_b32 v50, v50 offset:1024
    ds_read_b32 v51, v51 offset:1024
    ds_read_b32 v52, v52 offset:1024
    s_waitcnt lgkmcnt(4)
    v_add_u32 v48, v48, v56
    v_mul_u32_u24 v42, s61, v48
    v_add_u32_sdwa v42, v48, v42 dst_sel:DWORD dst_unused:UNUSED_PAD src0_sel:DWORD src1_sel:WORD_1
    v_lshlrev_b32 v56, 2, v42
    ds_write_b8_d16_hi v42, v36 offset:4096
    s_waitcnt lgkmcnt(4)
    v_add_u32 v49, v49, v57
    v_mul_u32_u24 v43, s61, v49
    v_add_u32_sdwa v43, v49, v43 dst_sel:DWORD dst_unused:UNUSED_PAD src0_sel:DWORD src1_sel:WORD_1
    v_lshlrev_b32 v57, 2, v43
    ds_write_b8_d16_hi v43, v37 offset:4096
    s_waitcnt lgkmcnt(4)
    v_add_u32 v50, v50, v58
    v_mul_u32_u24 v44, s61, v50
    v_add_u32_sdwa v44, v50, v44 dst_sel:DWORD dst_unused:UNUSED_PAD src0_sel:DWORD src1_sel:WORD_1
    v_lshlrev_b32 v58, 2, v44
    ds_write_b8_d16_hi v44, v38 offset:4096
    s_waitcnt lgkmcnt(4)
    v_add_u32 v51, v51, v59
    v_mul_u32_u24 v45, s61, v51
    v_add_u32_sdwa v45, v51, v45 dst_sel:DWORD dst_unused:UNUSED_PAD src0_sel:DWORD src1_sel:WORD_1
    v_lshlrev_b32 v59, 2, v45
    ds_write_b8_d16_hi v45, v39 offset:4096
    s_waitcnt lgkmcnt(4)
    v_add_u32 v52, v52, v60
    v_mul_u32_u24 v46, s61, v52
    v_add_u32_sdwa v46, v52, v46 dst_sel:DWORD dst_unused:UNUSED_PAD src0_sel:DWORD src1_sel:WORD_1
    v_lshlrev_b32 v60, 2, v46
    s_mov_b64 exec, s[68:69]
    ds_write_b8_d16_hi v46, v40 offset:4096
    s_cmp_ge_u32 s26, 3
    s_waitcnt vmcnt(7)
    s_cbranch_scc0 L_srcin
    s_waitcnt vmcnt(3)
L_srcin:
    v_or_b32 v28, v34, v28
    ds_write_b32 v60, v28 offset:8192
    s_mov_b64 exec, -1
    v_lshl_or_b32 v24, v32, 16, v24
    ds_write_b32 v56, v24 offset:8192
    v_and_or_b32 v25, v32, s63, v25
    ds_write_b32 v57, v25 offset:8192
    v_lshl_or_b32 v26, v33, 16, v26
    ds_write_b32 v58, v26 offset:8192
    v_and_or_b32 v27, v33, s63, v27
    ds_write_b32 v59, v27 offset:8192
    s_cmp_lg_u32 s26, 7
    s_cbranch_scc1 L_nopb
    v_mul_u32_u24 v2, s61, v8
    v_lshrrev_b32 v2, 16, v2
    v_add_lshl_u32 v8, v8, v2, 2
    v_mul_u32_u24 v2, s61, v9
    v_lshrrev_b32 v2, 16, v2
    v_add_lshl_u32 v9, v9, v2, 2
    v_mul_u32_u24 v2, s61, v10
    v_lshrrev_b32 v2, 16, v2
    v_add_lshl_u32 v10, v10, v2, 2
    v_mul_u32_u24 v2, s61, v11
    v_lshrrev_b32 v2, 16, v2
    v_add_lshl_u32 v11, v11, v2, 2
    v_mul_u32_u24 v2, s61, v3
    v_lshrrev_b32 v2, 16, v2
    v_add_lshl_u32 v3, v3, v2, 2
    v_lshl_or_b32 v152, v9, 16, v8
    v_lshl_or_b32 v153, v11, 16, v10
    v_mov_b32 v154, v3
L_nopb:
    s_waitcnt vmcnt(0)
    s_sub_u32 s61, s26, 3
    s_cmp_ge_u32 s61, 1
    s_cbranch_scc1 L_ple
    s_lshl_b32 s61, s61, 12
    v_lshlrev_b32 v6, 4, v254
L_pl:
    s_add_u32 m0, s61, 62592
    s_nop 0
    buffer_load_dwordx4 v6, s[32:35], s61 offen offset:0 lds
    buffer_load_dwordx4 v6, s[32:35], s61 offen offset:1024 lds
    buffer_load_dwordx4 v6, s[32:35], s61 offen offset:2048 lds
    buffer_load_dwordx4 v6, s[32:35], s61 offen offset:3072 lds
    s_add_u32 s61, s61, 4096
    s_cmp_lt_u32 s61, 20480
    s_cbranch_scc1 L_pl
L_ple:
    s_waitcnt lgkmcnt(0)
    s_add_u32 s40, s40, 2654435761
    v_mov_b32 v155, s40
    s_cmp_ge_u32 s26, 4
    s_waitcnt lgkmcnt(0)
    s_barrier
    s_cbranch_scc1 L_nost
    ds_read_b128 v[48:51], v137 offset:0
    ds_read_b32 v8, v138 offset:4096
    ds_read_b128 v[52:55], v137 offset:1024
    ds_read_b32 v9, v138 offset:4352
    ds_read_b128 v[56:59], v137 offset:2048
    ds_read_b32 v10, v138 offset:4608
    ds_read_b128 v[60:63], v137 offset:3072
    ds_read_b32 v11, v138 offset:4864
    s_and_b32 s36, s40, 0xc000
    s_lshl_b32 s60, s40, 2
    s_and_b32 s37, s60, 0xc000
    s_lshl_b32 s60, s40, 4
    s_and_b32 s38, s60, 0xc000
    s_and_b32 s39, s40, 4278387459
    s_waitcnt lgkmcnt(6)
    v_or_b32 v48, s36, v48
    v_or_b32 v49, s37, v49
    v_or_b32 v50, s38, v50
    v_and_or_b32 v51, v8, v139, s39
    global_store_dwordx4 v136, v[48:51], s[24:25] offset:0 sc1
    s_waitcnt lgkmcnt(4)
    s_mov_b64 exec, s[64:65]
    v_or_b32 v52, s36, v52
    v_or_b32 v53, s37, v53
    v_or_b32 v54, s38, v54
    v_and_or_b32 v55, v9, v139, s39
    global_store_dwordx4 v136, v[52:55], s[24:25] offset:1024 sc1
    s_waitcnt lgkmcnt(2)
    s_mov_b64 exec, s[66:67]
    v_or_b32 v56, s36, v56
    v_or_b32 v57, s37, v57
    v_or_b32 v58, s38, v58
    v_and_or_b32 v59, v10, v139, s39
    global_store_dwordx4 v136, v[56:59], s[24:25] offset:2048 sc1
    s_waitcnt lgkmcnt(0)
    v_or_b32 v60, s36, v60
    v_or_b32 v61, s37, v61
    v_or_b32 v62, s38, v62
    v_and_or_b32 v63, v11, v139, s39
    global_store_dwordx4 v136, v[60:63], s[24:25] offset:3072 sc1
    s_mov_b64 exec, -1
L_nost:
    s_cmp_lg_u32 s26, 7
    s_cbranch_scc1 L_nopub
    global_store_dwordx4 v69, v[152:155], s[24:25] sc1
L_nopub:
    s_and_b32 s36, s40, 0xc000
    s_lshl_b32 s60, s40, 2
    s_and_b32 s37, s60, 0xc000
    s_lshl_b32 s60, s40, 4
    s_and_b32 s38, s60, 0xc000
    s_and_b32 s39, s40, 4278387459
    s_mov_b32 s42, 2000000
    ds_read_u16_d16_hi v172, v68 offset:62208
    ds_read_u16_d16_hi v173, v68 offset:62336
    s_cmp_ge_u32 s26, 6
    s_cbranch_scc1 L_w67
    s_cmp_ge_u32 s26, 3
    s_cbranch_scc1 L_w345
    v_mov_b64 v[234:235], v[72:73]
    v_mov_b64 v[236:237], v[74:75]
    s_branch L_w05
L_w345:
    ds_read_b128 v[72:75], v145
    ds_read_b128 v[76:79], v146
    ds_read_b64_tr_b16 v[80:81], v148 offset:0
    ds_read_b64_tr_b16 v[82:83], v148 offset:512
    ds_read_b64_tr_b16 v[84:85], v148 offset:4096
    ds_read_b64_tr_b16 v[86:87], v148 offset:4608
    ds_read_b64_tr_b16 v[88:89], v149 offset:0
    ds_read_b64_tr_b16 v[90:91], v149 offset:512
    ds_read_b64_tr_b16 v[92:93], v149 offset:4096
    ds_read_b64_tr_b16 v[94:95], v149 offset:4608
    ds_read_b64_tr_b16 v[96:97], v150 offset:0
    ds_read_b64_tr_b16 v[98:99], v150 offset:512
    ds_read_b64_tr_b16 v[100:101], v150 offset:4096
    ds_read_b64_tr_b16 v[102:103], v150 offset:4608
    ds_read_b64_tr_b16 v[104:105], v151 offset:0
    ds_read_b64_tr_b16 v[106:107], v151 offset:512
    ds_read_b64_tr_b16 v[108:109], v151 offset:4096
    ds_read_b64_tr_b16 v[110:111], v151 offset:4608
    v_and_b32 v1, 15, v254
    v_lshrrev_b32 v3, 4, v254
    s_lshl_b32 s60, s46, 5
    s_add_u32 s60, s60, 55552
    v_lshl_add_u32 v2, v3, 3, s60
    v_mul_u32_u24 v1, 104, v1
    v_add_u32 v2, v1, v2
    s_mov_b32 s96, 0xbfb8aa3b
    s_waitcnt lgkmcnt(12)
    v_mfma_f32_16x16x32_bf16 v[112:115], v[72:75], v[80:83], 0
    v_mfma_f32_16x16x32_bf16 v[112:115], v[76:79], v[84:87], v[112:115]
    s_waitcnt lgkmcnt(8)
    v_mfma_f32_16x16x32_bf16 v[116:119], v[72:75], v[88:91], 0
    v_mfma_f32_16x16x32_bf16 v[116:119], v[76:79], v[92:95], v[116:119]
    s_waitcnt lgkmcnt(4)
    v_mfma_f32_16x16x32_bf16 v[120:123], v[72:75], v[96:99], 0
    v_mfma_f32_16x16x32_bf16 v[120:123], v[76:79], v[100:103], v[120:123]
    s_waitcnt lgkmcnt(0)
    v_mfma_f32_16x16x32_bf16 v[124:127], v[72:75], v[104:107], 0
    v_mfma_f32_16x16x32_bf16 v[124:127], v[76:79], v[108:111], v[124:127]
    s_nop 1
    v_pk_mul_f32 v[112:113], v[112:113], s[96:97] op_sel_hi:[1,0]
    v_pk_mul_f32 v[114:115], v[114:115], s[96:97] op_sel_hi:[1,0]
    v_pk_mul_f32 v[116:117], v[116:117], s[96:97] op_sel_hi:[1,0]
    v_pk_mul_f32 v[118:119], v[118:119], s[96:97] op_sel_hi:[1,0]
    v_pk_mul_f32 v[120:121], v[120:121], s[96:97] op_sel_hi:[1,0]
    v_pk_mul_f32 v[122:123], v[122:123], s[96:97] op_sel_hi:[1,0]
    v_pk_mul_f32 v[124:125], v[124:125], s[96:97] op_sel_hi:[1,0]
    v_pk_mul_f32 v[126:127], v[126:127], s[96:97] op_sel_hi:[1,0]
    v_cvt_pk_bf16_f32 v80, v112, v113
    v_cvt_pk_bf16_f32 v81, v114, v115
    v_cvt_pk_bf16_f32 v82, v116, v117
    v_cvt_pk_bf16_f32 v83, v118, v119
    v_cvt_pk_bf16_f32 v84, v120, v121
    v_cvt_pk_bf16_f32 v85, v122, v123
    v_cvt_pk_bf16_f32 v86, v124, v125
    v_cvt_pk_bf16_f32 v87, v126, v127
    v_mov_b64 v[234:235], v[76:77]
    v_mov_b64 v[236:237], v[78:79]
    ds_write_b64 v2, v[80:81] offset:0
    ds_write_b64 v2, v[82:83] offset:1664
    ds_write_b64 v2, v[84:85] offset:3328
    ds_write_b64 v2, v[86:87] offset:4992
L_w05:
    ds_read_b64_tr_b16 v[96:97], v144 offset:0
    ds_read_b64_tr_b16 v[98:99], v144 offset:512
    ds_read_b64_tr_b16 v[100:101], v144 offset:4096
    ds_read_b64_tr_b16 v[102:103], v144 offset:4608
    ds_read_b64_tr_b16 v[104:105], v144 offset:8
    ds_read_b64_tr_b16 v[106:107], v144 offset:520
    ds_read_b64_tr_b16 v[108:109], v144 offset:4104
    ds_read_b64_tr_b16 v[110:111], v144 offset:4616
    ds_read_b64_tr_b16 v[238:239], v144 offset:8192
    ds_read_b64_tr_b16 v[240:241], v144 offset:8704
    ds_read_b64_tr_b16 v[242:243], v144 offset:12288
    ds_read_b64_tr_b16 v[244:245], v144 offset:12800
    ds_read_b64_tr_b16 v[246:247], v144 offset:8200
    ds_read_b64_tr_b16 v[248:249], v144 offset:8712
    ds_read_b64_tr_b16 v[250:251], v144 offset:12296
    ds_read_b64_tr_b16 v[252:253], v144 offset:12808
    s_lshl_b32 s60, s46, 4
    v_and_b32 v1, 15, v254
    v_add_lshl_u32 v255, v1, s60, 2
    s_waitcnt lgkmcnt(8)
    v_mfma_f32_16x16x32_bf16 v[226:229], v[96:99], v[72:75], 0
    v_mfma_f32_16x16x32_bf16 v[226:229], v[100:103], v[76:79], v[226:229]
    v_mfma_f32_16x16x32_bf16 v[230:233], v[104:107], v[72:75], 0
    v_mfma_f32_16x16x32_bf16 v[230:233], v[108:111], v[76:79], v[230:233]
    v_and_b32 v2, 48, v254
    v_add_u32 v209, 53120, v2
    s_lshl_b32 s60, s45, 1
    s_add_u32 s60, s60, s47
    s_lshl_b32 s60, s60, 6
    v_lshl_add_u32 v2, v255, 5, v2
    v_add_u32 v12, s60, v2
    s_lshl_b32 s60, s55, 2
    v_cmp_gt_u32 s[4:5], s60, v255
    v_pk_mul_f32 v[226:227], v[226:227], s[96:97] op_sel_hi:[1,0]
    v_pk_mul_f32 v[228:229], v[228:229], s[96:97] op_sel_hi:[1,0]
    v_pk_mul_f32 v[230:231], v[230:231], s[96:97] op_sel_hi:[1,0]
    v_pk_mul_f32 v[232:233], v[232:233], s[96:97] op_sel_hi:[1,0]
    s_branch L_wdone
L_w67:
    ds_read_u16_d16_hi v4, v68 offset:62464
    v_and_b32 v6, 127, v0
    s_mul_i32 s61, s55, 3
    s_sub_u32 s60, s61, 1
    v_min_u32 v7, s60, v6
    s_mul_i32 s60, s45, 6
    v_lshl_add_u32 v1, v7, 1, s60
    global_load_short_d16_hi v230, v1, s[6:7]
    s_add_u32 s60, s60, 1280000
    v_lshl_add_u32 v12, v6, 1, s60
    v_cmp_gt_u32 s[4:5], s61, v6
    v_mul_u32_u24 v1, 171, v7
    v_lshrrev_b32 v1, 9, v1
    v_mad_i32_i24 v2, v1, -3, v7
    v_lshlrev_b32 v255, 2, v1
    v_lshl_add_u32 v226, v2, 8, v255
    v_lshlrev_b32 v209, 3, v2
    v_add_u32 v209, 53376, v209
    v_bfe_u32 v1, v254, 2, 1
    v_lshrrev_b32 v2, 3, v254
    v_and_b32 v3, 3, v254
    v_lshl_add_u32 v2, v2, 2, v3
    v_lshl_add_u32 v2, v1, 5, v2
    v_lshlrev_b32 v2, 2, v2
    s_waitcnt lgkmcnt(0)
    ds_write_b32 v2, v4 offset:3840
    v_lshlrev_b32 v2, 2, v254
    v_lshlrev_b32 v4, 3, v254
    ds_write_b32 v2, v4 offset:3584
L_wdone:
    v_mul_u32_u24 v1, 76, v255
    v_add_u32 v1, -12160, v1
    v_add_u32 v219, v1, v209
    v_mul_f32 v172, 0xbfb8aa3b, v172
    v_mul_f32 v173, 0xbfb8aa3b, v173
    v_cvt_pk_bf16_f32 v1, v172, v172
    v_and_b32 v1, 0xffff0000, v1
    v_sub_f32 v2, v172, v1
    v_cvt_pk_bf16_f32 v172, v1, v2
    v_mov_b32 v1, 0x21800000
    v_cvt_pk_bf16_f32 v173, v1, v173
    s_add_u32 s28, s24, 524288
    s_addc_u32 s29, s25, 0
    s_and_b32 s29, s29, 0xffff
    s_or_b32 s29, s29, 0x800000
    s_mov_b32 s30, 10000
    s_mov_b32 s31, 0x20000
    s_mov_b32 s41, 0
    s_mov_b32 s48, 0x3f80
    s_mov_b32 s49, 0
    s_movk_i32 s43, 0x80
    v_mov_b32 v195, 1048576
    v_lshrrev_b32 v1, 3, v0
    v_and_b32 v2, 7, v0
    v_lshlrev_b32 v133, 4, v2
    v_mul_u32_u24 v1, 13440, v1
    v_add_u32 v132, v1, v133
    v_mov_b32 v116, 0
    v_mov_b64 v[16:17], s[36:37]
    v_mov_b64 v[18:19], s[38:39]
    v_mov_b64 v[20:21], s[36:37]
    v_mov_b64 v[22:23], s[38:39]
    v_mov_b64 v[24:25], s[36:37]
    v_mov_b64 v[26:27], s[38:39]
    v_mov_b64 v[28:29], s[36:37]
    v_mov_b64 v[30:31], s[38:39]
    s_add_u32 s8, s24, 2097152
    s_addc_u32 s9, s25, 0
    s_add_u32 s10, s24, 2957312
    s_addc_u32 s11, s25, 0
    s_add_u32 s12, s24, 3817472
    s_addc_u32 s13, s25, 0
    s_add_u32 s14, s24, 4677632
    s_addc_u32 s15, s25, 0
    s_andn2_b32 s60, s2, 7
    s_add_u32 s60, s60, s26
    s_mul_i32 s60, s60, 40
    v_add_u32 v134, s60, v254
    s_bfm_b64 s[6:7], 23, 0
    v_lshlrev_b32 v5, 4, v0
    ds_write_b128 v5, v[156:159] offset:24576
    ds_write_b128 v5, v[156:159] offset:32768
    ds_write_b128 v5, v[156:159] offset:40960
    v_cmp_gt_u32 vcc, 400, v0
    s_mov_b64 exec, vcc
    ds_write_b128 v5, v[156:159] offset:49152
    s_mov_b64 exec, -1
    s_cmp_ge_u32 s26, 4
    s_cbranch_scc1 L_noz
    ds_write_b128 v137, v[156:159] offset:0
    ds_write_b128 v137, v[156:159] offset:1024
    ds_write_b128 v137, v[156:159] offset:2048
    ds_write_b128 v137, v[156:159] offset:3072
L_noz:
    v_and_b32 v1, 255, v0
    s_lshr_b32 s60, s27, 2
    s_lshl_b32 s60, s60, 4
    s_add_u32 s60, s60, 65536
    v_lshl_add_u32 v164, v1, 10, s60
    v_lshlrev_b32 v165, 2, v1
    s_cmp_lt_u32 s26, 4
    s_cbranch_scc1 L_nops
    global_load_dwordx4 v[160:163], v164, s[24:25] sc1
L_nops:
    v_lshrrev_b32 v1, 5, v254
    v_and_b32 v2, 1, v254
    v_lshlrev_b32 v225, 7, v1
    v_lshlrev_b32 v3, 5, v1
    v_lshl_add_u32 v187, v2, 4, v3
    v_bfe_u32 v4, v254, 3, 2
    v_bfe_u32 v5, v254, 1, 1
    v_lshl_add_u32 v4, v4, 1, v5
    v_bfe_u32 v5, v254, 2, 1
    v_lshl_add_u32 v4, v5, 3, v4
    v_lshlrev_b32 v218, 3, v4
    s_lshl_b32 s61, s26, 10
    s_add_u32 s61, s61, 155648
    v_lshl_add_u32 v190, v4, 4, s61
    v_xor_b32 v5, v1, v2
    v_lshl_add_u32 v190, v5, 20, v190
    v_lshl_add_u32 v193, v254, 4, s61
    s_lshl_b32 s61, s26, 12
    s_add_u32 s61, s61, 8192
    v_bfe_u32 v3, v254, 1, 3
    v_lshl_add_u32 v4, v254, 6, s61
    v_lshl_add_u32 v194, v3, 3, v4
    v_bfe_u32 v3, v254, 2, 2
    v_and_b32 v4, 3, v254
    v_bfe_u32 v5, v254, 4, 1
    v_lshl_add_u32 v5, v5, 2, v4
    v_lshrrev_b32 v7, 1, v3
    v_lshl_add_u32 v7, v1, 2, v7
    v_xor_b32 v5, v5, v7
    v_lshl_add_u32 v7, v1, 3, v3
    v_lshl_add_u32 v7, v7, 6, s61
    v_lshl_add_u32 v191, v5, 3, v7
    v_xor_b32 v192, 16, v191
    v_add_u32 v192, 256, v192
    v_and_b32 v4, 31, v254
    v_lshlrev_b32 v7, 3, v1
    v_sub_u32 v7, v4, v7
    v_lshlrev_b32 v4, 4, v2
    v_lshlrev_b32 v4, v4, s48
    v_ashrrev_i32 v7, 1, v7
    v_cmp_eq_u32 s[64:65], 0, v7
    v_cmp_eq_u32 s[66:67], 1, v7
    v_cmp_eq_u32 s[68:69], 2, v7
    v_cmp_eq_u32 s[70:71], 3, v7
    v_cndmask_b32 v176, 0, v4, s[64:65]
    v_cndmask_b32 v177, 0, v4, s[66:67]
    v_cndmask_b32 v178, 0, v4, s[68:69]
    v_cndmask_b32 v179, 0, v4, s[70:71]
    v_cmp_eq_u32 s[64:65], 8, v7
    v_cmp_eq_u32 s[66:67], 9, v7
    v_cmp_eq_u32 s[68:69], 10, v7
    v_cmp_eq_u32 s[70:71], 11, v7
    v_cndmask_b32 v180, 0, v4, s[64:65]
    v_cndmask_b32 v181, 0, v4, s[66:67]
    v_cndmask_b32 v182, 0, v4, s[68:69]
    v_cndmask_b32 v183, 0, v4, s[70:71]
    v_xor_b32 v7, 1, v1
    v_mul_u32_u24 v184, 16256, v7
    v_mov_b32 v185, 0
L_nolc:
    v_lshrrev_b32 v6, 3, v0
    v_lshlrev_b32 v6, 2, v6
    s_cmp_lt_u32 s26, 4
    s_cbranch_scc1 L_b3
    s_and_b32 s3, s27, 1
    s_lshl_b32 s3, s3, 4
L_poll:
    s_sub_u32 s42, s42, 1
    s_waitcnt vmcnt(0)
    v_cmp_ne_u32 vcc, s40, v163
    s_cbranch_scc1 L_pollout
    s_cbranch_vccz L_gotoff
    s_mov_b64 exec, vcc
    global_load_dwordx4 v[160:163], v164, s[24:25] sc1
    s_branch L_poll
L_gotoff:
    s_mov_b64 exec, -1
    s_bitcmp1_b32 s27, 1
    v_alignbit_b32 v3, v161, v160, s3
    v_alignbit_b32 v4, v162, v161, s3
    s_cselect_b64 vcc, -1, 0
    v_cndmask_b32 v3, v3, v4, vcc
    ds_write_b32 v165, v3 offset:1024
    s_cmp_lt_u32 s26, 6
    s_cbranch_scc1 L_b3
    ds_write_b32 v226, v230 offset:2816
L_b3:
    s_waitcnt lgkmcnt(0)
    s_barrier
    ds_read2st64_b32 v[220:221], v6 offset0:4 offset1:5
    ds_read2st64_b32 v[222:223], v6 offset0:6 offset1:7
    s_waitcnt lgkmcnt(0)
L_fetch:
    v_and_b32 v112, 0xfff0, v220
    v_sub_u32_sdwa v117, v220, v112 dst_sel:DWORD dst_unused:UNUSED_PAD src0_sel:WORD_1 src1_sel:DWORD
    v_add_u32 v112, v112, v132
    v_cmp_lt_i32 vcc, v133, v117
    s_mov_b64 exec, vcc
    global_load_dwordx4 v[16:19], v112, s[8:9] sc1
    s_mov_b64 exec, -1
    v_and_b32 v113, 0xfff0, v221
    v_sub_u32_sdwa v118, v221, v113 dst_sel:DWORD dst_unused:UNUSED_PAD src0_sel:WORD_1 src1_sel:DWORD
    v_add_u32 v113, v113, v132
    v_cmp_lt_i32 vcc, v133, v118
    s_mov_b64 exec, vcc
    global_load_dwordx4 v[20:23], v113, s[10:11] sc1
    s_mov_b64 exec, -1
    v_and_b32 v114, 0xfff0, v222
    v_sub_u32_sdwa v119, v222, v114 dst_sel:DWORD dst_unused:UNUSED_PAD src0_sel:WORD_1 src1_sel:DWORD
    v_add_u32 v114, v114, v132
    v_cmp_lt_i32 vcc, v133, v119
    s_mov_b64 exec, vcc
    global_load_dwordx4 v[24:27], v114, s[12:13] sc1
    s_mov_b64 exec, -1
    v_and_b32 v115, 0xfff0, v223
    v_sub_u32_sdwa v120, v223, v115 dst_sel:DWORD dst_unused:UNUSED_PAD src0_sel:WORD_1 src1_sel:DWORD
    v_add_u32 v115, v115, v132
    v_cmp_lt_i32 vcc, v133, v120
    s_mov_b64 exec, vcc
    global_load_dwordx4 v[28:31], v115, s[14:15] sc1
    s_mov_b64 exec, -1
    v_max3_i32 v3, v117, v118, v119
    v_max_i32 v3, v3, v120
    v_mov_b32 v13, 8
    v_cmp_lt_i32 vcc, s43, v3
    s_or_b32 s17, vcc_lo, vcc_hi
    s_cbranch_scc0 L_nob0
    s_cmp_eq_u32 s43, 48
    s_cbranch_scc1 L_narrow
    v_mov_b32 v121, 0
    v_mov_b32 v4, 0
    v_cmp_lt_i32 vcc, 0x80, v120
    v_add_u32 v5, 2580480, v115
    s_nop 0
    v_cndmask_b32 v121, v121, v120, vcc
    v_cndmask_b32 v116, v116, v5, vcc
    v_addc_co_u32 v4, vcc, 0, v4, vcc
    v_cmp_lt_i32 vcc, 0x80, v119
    v_add_u32 v5, 1720320, v114
    s_nop 0
    v_cndmask_b32 v121, v121, v119, vcc
    v_cndmask_b32 v116, v116, v5, vcc
    v_addc_co_u32 v4, vcc, 0, v4, vcc
    v_cmp_lt_i32 vcc, 0x80, v118
    v_add_u32 v5, 860160, v113
    s_nop 0
    v_cndmask_b32 v121, v121, v118, vcc
    v_cndmask_b32 v116, v116, v5, vcc
    v_addc_co_u32 v4, vcc, 0, v4, vcc
    v_cmp_lt_i32 vcc, 0x80, v117
    v_add_u32 v5, 0, v112
    s_nop 0
    v_cndmask_b32 v121, v121, v117, vcc
    v_cndmask_b32 v116, v116, v5, vcc
    v_addc_co_u32 v4, vcc, 0, v4, vcc
    v_subrev_u32 v131, 0x80, v121
    v_max_i32 v131, 0, v131
    v_mov_b64 v[32:33], s[36:37]
    v_mov_b64 v[34:35], s[38:39]
    v_cmp_lt_i32 s[94:95], v133, v131
    v_cmp_lt_i32 vcc, 0x100, v3
    v_cmp_lt_i32 s[60:61], 1, v4
    s_mov_b64 exec, s[94:95]
    global_load_dwordx4 v[32:35], v116, s[8:9] offset:128 sc1
    s_or_b64 exec, vcc, s[60:61]
    ds_write_b32 v216, v13 offset:2300
    s_mov_b64 exec, -1
    v_add_u32 v5, 0, v133
    v_cmp_lt_u32 s[88:89], v5, v131
    v_add_u32 v5, 4, v133
    v_cmp_lt_u32 s[90:91], v5, v131
    v_add_u32 v5, 8, v133
    v_cmp_lt_u32 s[92:93], v5, v131
L_nob0:
    v_and_b32 v4, 15, v220
    v_sub_u32 v127, v117, v4
    v_sub_u32 v4, v133, v4
    v_add_u32 v5, 4, v4
    v_add_u32 v6, 8, v4
    v_cmp_lt_u32 s[64:65], v4, v127
    v_cmp_lt_u32 s[66:67], v5, v127
    v_cmp_lt_u32 s[68:69], v6, v127
    v_and_b32 v4, 15, v221
    v_sub_u32 v128, v118, v4
    v_sub_u32 v4, v133, v4
    v_add_u32 v5, 4, v4
    v_add_u32 v6, 8, v4
    v_cmp_lt_u32 s[70:71], v4, v128
    v_cmp_lt_u32 s[72:73], v5, v128
    v_cmp_lt_u32 s[74:75], v6, v128
    v_and_b32 v4, 15, v222
    v_sub_u32 v129, v119, v4
    v_sub_u32 v4, v133, v4
    v_add_u32 v5, 4, v4
    v_add_u32 v6, 8, v4
    v_cmp_lt_u32 s[76:77], v4, v129
    v_cmp_lt_u32 s[78:79], v5, v129
    v_cmp_lt_u32 s[80:81], v6, v129
    v_and_b32 v4, 15, v223
    v_sub_u32 v130, v120, v4
    v_sub_u32 v4, v133, v4
    v_add_u32 v5, 4, v4
    v_add_u32 v6, 8, v4
    v_cmp_lt_u32 s[82:83], v4, v130
    v_cmp_lt_u32 s[84:85], v5, v130
    v_cmp_lt_u32 s[86:87], v6, v130
    v_lshlrev_b32 v1, 2, v254
    v_cmp_gt_u32 s[58:59], s55, v254
    v_mov_b32 v7, 4278387459
    s_movk_i32 s62, 0xfc
    s_mov_b32 s63, 0xc000
    s_waitcnt vmcnt(3)
L_chk0:
    v_xor_b32 v4, s36, v16
    v_bitop3_b32 v5, v19, s39, v7 bitop3:0x28
    v_bitop3_b32 v4, v4, v17, s37 bitop3:0xf6
    v_bitop3_b32 v4, v4, v18, s38 bitop3:0xf6
    v_and_or_b32 v4, v4, s63, v5
    v_cmp_ne_u32 vcc, 0, v4
    v_and_b32_sdwa v36, s62, v19 dst_sel:DWORD dst_unused:UNUSED_PAD src0_sel:DWORD src1_sel:BYTE_0
    v_and_b32_sdwa v38, s62, v19 dst_sel:DWORD dst_unused:UNUSED_PAD src0_sel:DWORD src1_sel:BYTE_1
    v_and_b32_sdwa v40, s62, v19 dst_sel:DWORD dst_unused:UNUSED_PAD src0_sel:DWORD src1_sel:BYTE_2
    s_cbranch_vccnz L_stale0
L_got0:
    s_mov_b64 exec, s[64:65]
    ds_add_rtn_u32 v80, v36, v13 offset:2048
    s_mov_b64 exec, s[66:67]
    ds_add_rtn_u32 v81, v38, v13 offset:2048
    s_mov_b64 exec, s[68:69]
    ds_add_rtn_u32 v82, v40, v13 offset:2048
    s_mov_b64 exec, -1
    s_waitcnt vmcnt(2)
L_chk1:
    v_xor_b32 v4, s36, v20
    v_bitop3_b32 v5, v23, s39, v7 bitop3:0x28
    v_bitop3_b32 v4, v4, v21, s37 bitop3:0xf6
    v_bitop3_b32 v4, v4, v22, s38 bitop3:0xf6
    v_and_or_b32 v4, v4, s63, v5
    v_cmp_ne_u32 vcc, 0, v4
    v_and_b32_sdwa v42, s62, v23 dst_sel:DWORD dst_unused:UNUSED_PAD src0_sel:DWORD src1_sel:BYTE_0
    v_and_b32_sdwa v44, s62, v23 dst_sel:DWORD dst_unused:UNUSED_PAD src0_sel:DWORD src1_sel:BYTE_1
    v_and_b32_sdwa v46, s62, v23 dst_sel:DWORD dst_unused:UNUSED_PAD src0_sel:DWORD src1_sel:BYTE_2
    s_cbranch_vccnz L_stale1
L_got1:
    s_mov_b64 exec, s[70:71]
    ds_add_rtn_u32 v83, v42, v13 offset:2048
    s_mov_b64 exec, s[72:73]
    ds_add_rtn_u32 v84, v44, v13 offset:2048
    s_mov_b64 exec, s[74:75]
    ds_add_rtn_u32 v85, v46, v13 offset:2048
    s_mov_b64 exec, -1
    s_mul_i32 s60, s26, 5120
    s_add_u32 s60, s60, 20480
    s_add_u32 m0, s60, 62592
    v_lshlrev_b32 v6, 4, v254
    buffer_load_dwordx4 v6, s[32:35], s60 offen offset:0 lds
    buffer_load_dwordx4 v6, s[32:35], s60 offen offset:1024 lds
    buffer_load_dwordx4 v6, s[32:35], s60 offen offset:2048 lds
    buffer_load_dwordx4 v6, s[32:35], s60 offen offset:3072 lds
    s_waitcnt vmcnt(5)
L_chk2:
    v_xor_b32 v4, s36, v24
    v_bitop3_b32 v5, v27, s39, v7 bitop3:0x28
    v_bitop3_b32 v4, v4, v25, s37 bitop3:0xf6
    v_bitop3_b32 v4, v4, v26, s38 bitop3:0xf6
    v_and_or_b32 v4, v4, s63, v5
    v_cmp_ne_u32 vcc, 0, v4
    v_and_b32_sdwa v48, s62, v27 dst_sel:DWORD dst_unused:UNUSED_PAD src0_sel:DWORD src1_sel:BYTE_0
    v_and_b32_sdwa v50, s62, v27 dst_sel:DWORD dst_unused:UNUSED_PAD src0_sel:DWORD src1_sel:BYTE_1
    v_and_b32_sdwa v52, s62, v27 dst_sel:DWORD dst_unused:UNUSED_PAD src0_sel:DWORD src1_sel:BYTE_2
    s_cbranch_vccnz L_stale2
L_got2:
    s_mov_b64 exec, s[76:77]
    ds_add_rtn_u32 v86, v48, v13 offset:2048
    s_mov_b64 exec, s[78:79]
    ds_add_rtn_u32 v87, v50, v13 offset:2048
    s_mov_b64 exec, s[80:81]
    ds_add_rtn_u32 v88, v52, v13 offset:2048
    s_mov_b64 exec, -1
    s_mul_i32 s60, s26, 5120
    s_add_u32 s60, s60, 24576
    s_add_u32 m0, s60, 62592
    v_lshlrev_b32 v6, 4, v254
    buffer_load_dwordx4 v6, s[32:35], s60 offen offset:0 lds
    s_waitcnt vmcnt(5)
L_chk3:
    v_xor_b32 v4, s36, v28
    v_bitop3_b32 v5, v31, s39, v7 bitop3:0x28
    v_bitop3_b32 v4, v4, v29, s37 bitop3:0xf6
    v_bitop3_b32 v4, v4, v30, s38 bitop3:0xf6
    v_and_or_b32 v4, v4, s63, v5
    v_cmp_ne_u32 vcc, 0, v4
    v_and_b32_sdwa v54, s62, v31 dst_sel:DWORD dst_unused:UNUSED_PAD src0_sel:DWORD src1_sel:BYTE_0
    v_and_b32_sdwa v56, s62, v31 dst_sel:DWORD dst_unused:UNUSED_PAD src0_sel:DWORD src1_sel:BYTE_1
    v_and_b32_sdwa v58, s62, v31 dst_sel:DWORD dst_unused:UNUSED_PAD src0_sel:DWORD src1_sel:BYTE_2
    s_cbranch_vccnz L_stale3
L_got3:
    s_mov_b64 exec, s[82:83]
    ds_add_rtn_u32 v89, v54, v13 offset:2048
    s_mov_b64 exec, s[84:85]
    ds_add_rtn_u32 v90, v56, v13 offset:2048
    s_mov_b64 exec, s[86:87]
    ds_add_rtn_u32 v91, v58, v13 offset:2048
    s_mov_b64 exec, -1
    s_mov_b64 exec, s[6:7]
    buffer_load_dword v135, v134, s[28:31], 0 idxen
    s_mov_b64 exec, -1
    s_cmp_eq_u32 s17, 0
    s_cbranch_scc1 L_ba
L_chk4:
    v_xor_b32 v4, s36, v32
    v_bitop3_b32 v5, v35, s39, v7 bitop3:0x28
    v_bitop3_b32 v4, v4, v33, s37 bitop3:0xf6
    v_bitop3_b32 v4, v4, v34, s38 bitop3:0xf6
    v_and_or_b32 v4, v4, s63, v5
    v_cmp_ne_u32 vcc, 0, v4
    v_and_b32_sdwa v60, s62, v35 dst_sel:DWORD dst_unused:UNUSED_PAD src0_sel:DWORD src1_sel:BYTE_0
    v_and_b32_sdwa v62, s62, v35 dst_sel:DWORD dst_unused:UNUSED_PAD src0_sel:DWORD src1_sel:BYTE_1
    v_and_b32_sdwa v64, s62, v35 dst_sel:DWORD dst_unused:UNUSED_PAD src0_sel:DWORD src1_sel:BYTE_2
    s_cbranch_vccnz L_stale4
L_got4:
    s_mov_b64 exec, s[88:89]
    ds_add_rtn_u32 v92, v60, v13 offset:2048
    s_mov_b64 exec, s[90:91]
    ds_add_rtn_u32 v93, v62, v13 offset:2048
    s_mov_b64 exec, s[92:93]
    ds_add_rtn_u32 v94, v64, v13 offset:2048
    s_mov_b64 exec, -1
L_ba:
    s_waitcnt lgkmcnt(0)
    s_barrier
    ds_read_b32 v2, v1 offset:2048
    v_xor_b32 v37, s36, v16
    v_xor_b32 v39, s37, v17
    v_xor_b32 v41, s38, v18
    v_xor_b32 v43, s36, v20
    v_xor_b32 v45, s37, v21
    s_waitcnt lgkmcnt(0)
    v_max_u32 v4, 256, v2
    v_cndmask_b32 v5, 0, v4, s[58:59]
    v_subrev_u32 v6, 124032, v4
    v_readlane_b32 s57, v2, 63
    v_cmp_lt_u32 vcc, v2, v4
    v_add_u32_dpp v5, v5, v5 row_shr:1 row_mask:0xf bank_mask:0xf bound_ctrl:1
    v_xor_b32 v47, s38, v22
    v_xor_b32 v49, s36, v24
    v_add_u32_dpp v5, v5, v5 row_shr:2 row_mask:0xf bank_mask:0xf bound_ctrl:1
    v_xor_b32 v51, s37, v25
    v_xor_b32 v53, s38, v26
    v_add_u32_dpp v5, v5, v5 row_shr:4 row_mask:0xf bank_mask:0xf bound_ctrl:1
    v_xor_b32 v55, s36, v28
    v_xor_b32 v57, s37, v29
    v_add_u32_dpp v5, v5, v5 row_shr:8 row_mask:0xf bank_mask:0xf bound_ctrl:1
    v_xor_b32 v59, s38, v30
    v_xor_b32 v61, s36, v32
    v_add_u32_dpp v5, v5, v5 row_bcast:15 row_mask:0xa bank_mask:0xf
    v_xor_b32 v63, s37, v33
    v_xor_b32 v65, s38, v34
    v_add_u32_dpp v5, v5, v5 row_bcast:31 row_mask:0xc bank_mask:0xf
    v_sub_u32 v6, v5, v6
    ds_write_b32 v1, v6 offset:2560
    v_readlane_b32 s3, v5, 63
    ds_read_b32 v96, v36 offset:2560
    ds_read_b32 v97, v38 offset:2560
    ds_read_b32 v98, v40 offset:2560
    s_cmp_gt_u32 s3, 31104
    s_cbranch_scc1 L_redo
    s_and_b64 vcc, vcc, s[58:59]
    s_cbranch_scc1 L_pad0
L_nopad:
    ds_read_b32 v99, v42 offset:2560
    s_add_u32 s96, s3, 127
    s_lshr_b32 s60, s96, 10
    s_bfe_u32 s61, s96, 0x30007
    s_mul_i32 s62, s60, s26
    ds_read_b32 v100, v44 offset:2560
    s_min_u32 s63, s61, s26
    s_add_u32 s62, s62, s63
    s_cmp_lt_u32 s26, s61
    s_addc_u32 s52, s60, 0
    ds_read_b32 v101, v46 offset:2560
    s_lshl_b32 s62, s62, 7
    s_lshl_b32 s63, s52, 7
    s_add_u32 s63, s63, s62
    s_sub_u32 s97, s55, 1
    ds_read_b32 v102, v48 offset:2560
    v_cmp_ge_u32 vcc, s62, v5
    v_cmp_gt_u32 s[60:61], s63, v5
    s_add_u32 s62, s62, 124032
    ds_read_b32 v103, v50 offset:2560
    ds_read_b32 v104, v52 offset:2560
    ds_read_b32 v105, v54 offset:2560
    ds_read_b32 v106, v56 offset:2560
    ds_read_b32 v107, v58 offset:2560
    s_cmp_eq_u32 s17, 0
    s_cbranch_scc1 L_bl
    ds_read_b32 v108, v60 offset:2560
    ds_read_b32 v109, v62 offset:2560
    ds_read_b32 v110, v64 offset:2560
L_bl:
    s_mov_b64 exec, s[64:65]
    s_waitcnt lgkmcnt(9)
    v_add_u32 v96, v96, v80
    ds_write_b64 v96, v[36:37]
    s_mov_b64 exec, -1
    v_lshl_add_u32 v189, v254, 3, s62
    v_add3_u32 v188, s62, 4, v218
    v_mov_b32 v73, v187
    v_mov_b32 v75, v187
    s_mov_b64 exec, s[66:67]
    v_add_u32 v97, v97, v81
    ds_write_b64 v97, v[38:39]
    s_bcnt1_i32_b64 s50, vcc
    s_lshl_b32 s53, s50, 2
    s_bcnt1_i32_b64 s51, s[60:61]
    s_min_u32 s51, s51, s97
    s_mov_b64 exec, s[68:69]
    v_add_u32 v98, v98, v82
    ds_write_b64 v98, v[40:41]
    s_lshl_b32 s51, s51, 2
    s_sub_u32 s63, s51, s53
    s_cmp_ge_u32 s63, 32
    s_cselect_b32 s63, 248, s53
    s_mov_b64 exec, s[70:71]
    s_waitcnt lgkmcnt(9)
    v_add_u32 v99, v99, v83
    ds_write_b64 v99, v[42:43]
    s_mov_b64 exec, 1
    v_mov_b32 v7, s63
    s_lshl_b32 s63, 1, s26
    v_mov_b32 v8, s63
    ds_or_b32 v7, v8 offset:2304
    s_mov_b64 exec, s[72:73]
    v_add_u32 v100, v100, v84
    ds_write_b64 v100, v[44:45]
    s_lshl_b32 s63, s26, 6
    s_add_u32 s3, s3, s63
    s_add_u32 s3, s3, 124032
    s_sub_u32 s52, s52, 3
    s_mov_b64 exec, s[74:75]
    v_add_u32 v101, v101, v85
    ds_write_b64 v101, v[46:47]
    s_mov_b64 exec, 0xff
    v_lshl_add_u32 v9, v1, 1, s3
    v_lshlrev_b32 v10, 2, s97
    v_mov_b32 v11, 32512
    ds_write_b64 v9, v[10:11]
    s_mov_b64 exec, s[76:77]
    s_waitcnt lgkmcnt(9)
    v_add_u32 v102, v102, v86
    ds_write_b64 v102, v[48:49]
    s_mov_b64 exec, s[78:79]
    v_add_u32 v103, v103, v87
    ds_write_b64 v103, v[50:51]
    s_mov_b64 exec, s[80:81]
    v_add_u32 v104, v104, v88
    ds_write_b64 v104, v[52:53]
    s_mov_b64 exec, s[82:83]
    s_waitcnt lgkmcnt(9)
    v_add_u32 v105, v105, v89
    ds_write_b64 v105, v[54:55]
    s_mov_b64 exec, s[84:85]
    v_add_u32 v106, v106, v90
    ds_write_b64 v106, v[56:57]
    s_mov_b64 exec, s[86:87]
    v_add_u32 v107, v107, v91
    ds_write_b64 v107, v[58:59]
    s_cmp_eq_u32 s17, 0
    s_cbranch_scc1 L_bw
    s_mov_b64 exec, s[88:89]
    s_waitcnt lgkmcnt(9)
    v_add_u32 v108, v108, v92
    ds_write_b64 v108, v[60:61]
    s_mov_b64 exec, s[90:91]
    v_add_u32 v109, v109, v93
    ds_write_b64 v109, v[62:63]
    s_mov_b64 exec, s[92:93]
    v_add_u32 v110, v110, v94
    ds_write_b64 v110, v[64:65]
L_bw:
    s_mov_b64 exec, -1
    s_setprio 3
    s_waitcnt vmcnt(1) lgkmcnt(0)
    s_barrier
    ds_read_u16 v72, v188
    ds_read_b64 v[200:201], v189 offset:0
    ds_read_u16 v74, v188 offset:128
    ds_read_u16 v186, v188 offset:256
    v_mfma_f32_32x32x8_bf16 v[80:95], v[216:217], v[216:217], 0
    v_mfma_f32_32x32x8_bf16 v[96:111], v[216:217], v[216:217], 0
    s_waitcnt lgkmcnt(3)
    buffer_load_dwordx4 v[120:123], v[72:73], s[28:31], 0 idxen offen
    buffer_load_dwordx4 v[124:127], v[72:73], s[28:31], 0 idxen offen offset:64
    s_waitcnt lgkmcnt(2)
    v_mul_u32_u24_sdwa v214, 6, v201 dst_sel:DWORD dst_unused:UNUSED_PAD src0_sel:DWORD src1_sel:WORD_0
    ds_read_u16_d16_hi v206, v214 offset:62592
    ds_read_u16_d16_hi v207, v214 offset:62594
    ds_read_u16_d16_hi v208, v214 offset:62596
    ds_read2st64_b32 v[210:211], v200 offset0:11 offset1:12
    ds_read2st64_b32 v[212:213], v200 offset0:13 offset1:14
    ds_write_b64 v195, v[216:217]
    v_readlane_b32 s54, v200, 0
    s_and_b32 s60, s54, -8
    s_mul_i32 s56, s60, -4
    s_lshr_b32 s60, s60, 1
    v_lshl_add_u32 v215, v200, 2, s56
    v_add_u32 v197, s60, v196
    v_lshlrev_b64 v[202:203], v215, s[48:49]
    s_waitcnt lgkmcnt(1)
    v_sub_f32 v212, v212, v208
    v_cvt_pk_bf16_f32 v205, v212, 1.0
    v_lshlrev_b32 v215, 16, v205
    v_mul_f32 v214, v215, v215
    v_pk_add_f32 v[210:211], v[210:211], v[206:207] neg_lo:[0,1] neg_hi:[0,1]
    v_cvt_pk_bf16_f32 v204, v210, v211
    v_dot2_f32_bf16 v214, v204, v204, v214
    v_bitop3_b32 v195, v213, 56, v194 bitop3:0x6a
    ds_read_b32 v224, v255 offset:2304
    ds_read_b32 v2, v216 offset:2552
    v_cvt_pk_bf16_f32 v200, v214, v214
    ds_write_b128 v193, v[200:203]
    ds_write_b64 v195, v[204:205]
    ds_read2_b32 v[174:175], v197 offset1:1
    ds_read_b128 v[168:171], v190 offset:0
    ds_read_b64_tr_b16 v[152:153], v191 offset:0
    ds_read_b64_tr_b16 v[154:155], v192 offset:0
    ds_read_b64 v[200:201], v189 offset:512
    ds_write_b32 v1, v216 offset:2048
    buffer_load_dwordx4 v[128:131], v[74:75], s[28:31], 0 idxen offen
    buffer_load_dwordx4 v[132:135], v[74:75], s[28:31], 0 idxen offen offset:64
    s_or_b32 s16, s41, s57
    s_waitcnt lgkmcnt(8)
    v_readfirstlane_b32 s60, v2
    s_or_b32 s16, s16, s60
    s_cselect_b32 s50, 252, s53
    s_cselect_b32 s60, 0, -1
    v_and_b32 v224, s60, v224
    v_subrev_u32 v4, s53, v254
    v_and_b32 v4, 28, v4
    v_add_u32 v4, s53, v4
    v_cmp_eq_u32 vcc, s50, v4
    v_cmp_lt_u32 s[62:63], s51, v4
    s_lshl_b32 s61, s26, 2
    s_add_u32 s61, s61, 160
    v_mov_b32 v7, s61
    v_cndmask_b32 v4, v4, v7, vcc
    v_mov_b32 v7, 16384
    v_cndmask_b32 v4, v4, v7, s[62:63]
    v_mul_u32_u24 v4, 76, v4
    v_add_u32 v4, 40960, v4
    v_lshrrev_b32 v7, 5, v254
    v_lshl_add_u32 v198, v7, 4, v4
    v_lshl_add_u32 v4, v7, 2, v4
    v_and_b32 v7, 3, v254
    v_lshl_add_u32 v199, v7, 3, v4
    v_xor_b32 v7, 3, v7
    v_lshl_add_u32 v198, v7, 20, v198
    v_ffbl_b32 v5, v224
    v_add_u32 v6, -1, v224
    v_min_u32 v5, 4096, v5
    v_and_b32 v224, v6, v224
    v_mul_u32_u24 v5, 304, v5
    v_add_u32 v3, v209, v5
    s_waitcnt lgkmcnt(0)
    v_mfma_f32_32x32x16_bf16 v[16:31], v[168:171], v[172:175], 0
    ds_read_b128 v[136:139], v225 offset:3840
    ds_read_b128 v[140:143], v225 offset:3856
    ds_read_b128 v[144:147], v225 offset:3872
    ds_read_b128 v[148:151], v225 offset:3888
    s_waitcnt vmcnt(2)
    v_mfma_f32_32x32x16_bf16 v[16:31], v[120:123], v[176:179], v[16:31]
    v_mfma_f32_32x32x16_bf16 v[16:31], v[124:127], v[180:183], v[16:31]
    s_nop 4
    s_setprio 0
    buffer_load_dwordx4 v[120:123], v[186:187], s[28:31], 0 idxen offen
    buffer_load_dwordx4 v[124:127], v[186:187], s[28:31], 0 idxen offen offset:64
    ds_read_u16 v186, v188 offset:384
    ds_read_b128 v[168:171], v190 offset:256
    ds_read_b64_tr_b16 v[156:157], v191 offset:1024
    ds_read_b64_tr_b16 v[158:159], v192 offset:1024
    v_exp_f32 v48, v16
    v_exp_f32 v49, v17
    v_mul_u32_u24_sdwa v214, 6, v201 dst_sel:DWORD dst_unused:UNUSED_PAD src0_sel:DWORD src1_sel:WORD_0
    s_setprio 1
    v_exp_f32 v50, v18
    v_exp_f32 v51, v19
    v_exp_f32 v52, v20
    v_exp_f32 v53, v21
    v_exp_f32 v54, v22
    v_exp_f32 v55, v23
    v_exp_f32 v56, v24
    v_exp_f32 v57, v25
    v_exp_f32 v58, v26
    v_exp_f32 v59, v27
    v_exp_f32 v60, v28
    v_exp_f32 v61, v29
    v_exp_f32 v62, v30
    v_exp_f32 v63, v31
    s_setprio 2
    s_nop 0
    v_mfma_f32_32x32x8_bf16 v[48:63], v[184:185], v[184:185], v[48:63]
    s_nop 7
    s_sub_u32 s52, s52, 1
    s_waitcnt vmcnt(2) lgkmcnt(0)
    v_mfma_f32_32x32x16_bf16 v[32:47], v[128:131], v[176:179], 0
    s_setprio 3
    v_rcp_f32 v48, v48
    v_rcp_f32 v49, v49
    v_rcp_f32 v50, v50
    v_mfma_f32_32x32x16_bf16 v[32:47], v[132:135], v[180:183], v[32:47]
    v_rcp_f32 v51, v51
    v_rcp_f32 v52, v52
    v_rcp_f32 v53, v53
    v_mfma_f32_32x32x16_bf16 v[32:47], v[168:171], v[172:175], v[32:47]
    v_rcp_f32 v54, v54
    v_rcp_f32 v55, v55
    v_rcp_f32 v56, v56
    v_rcp_f32 v57, v57
    v_rcp_f32 v58, v58
    v_rcp_f32 v59, v59
    v_rcp_f32 v60, v60
    v_rcp_f32 v61, v61
    v_rcp_f32 v62, v62
    v_rcp_f32 v63, v63
    s_cbranch_scc1 L_evt0
    s_branch L_s1
.p2align 6
L_s0:
    s_setprio 0
    buffer_load_dwordx4 v[120:123], v[186:187], s[28:31], 0 idxen offen
    buffer_load_dwordx4 v[124:127], v[186:187], s[28:31], 0 idxen offen offset:64
    ds_read_u16 v186, v188 offset:384
    ds_read_b128 v[168:171], v190 offset:256
    ds_read_b64_tr_b16 v[156:157], v191 offset:1024
    ds_read_b64_tr_b16 v[158:159], v192 offset:1024
    v_exp_f32 v48, v16
    v_exp_f32 v49, v17
    v_mul_u32_u24_sdwa v214, 6, v201 dst_sel:DWORD dst_unused:UNUSED_PAD src0_sel:DWORD src1_sel:WORD_0
    s_setprio 1
    v_exp_f32 v50, v18
    v_exp_f32 v51, v19
    v_exp_f32 v52, v20
    v_exp_f32 v53, v21
    v_exp_f32 v54, v22
    v_exp_f32 v55, v23
    v_exp_f32 v56, v24
    v_exp_f32 v57, v25
    v_exp_f32 v58, v26
    v_exp_f32 v59, v27
    v_exp_f32 v60, v28
    v_exp_f32_e64 v61, v29
    v_exp_f32 v62, v30
    v_exp_f32_e64 v63, v31
    s_setprio 2
    v_pk_mul_f32 v[64:65], v[64:65], v[32:33]
    v_pk_mul_f32 v[66:67], v[66:67], v[34:35]
    v_pk_mul_f32 v[68:69], v[68:69], v[36:37]
    v_pk_mul_f32 v[70:71], v[70:71], v[38:39]
    v_pk_mul_f32 v[72:73], v[72:73], v[40:41]
    v_pk_mul_f32 v[74:75], v[74:75], v[42:43]
    v_pk_mul_f32 v[76:77], v[76:77], v[44:45]
    v_pk_mul_f32 v[78:79], v[78:79], v[46:47]
    v_mfma_f32_32x32x8_bf16 v[48:63], v[184:185], v[184:185], v[48:63]
    v_cvt_pk_bf16_f32 v112, v64, v66
    v_cvt_pk_bf16_f32 v116, v65, v67
    v_cvt_pk_bf16_f32 v113, v68, v70
    v_cvt_pk_bf16_f32 v117, v69, v71
    v_cvt_pk_bf16_f32 v114, v72, v74
    v_cvt_pk_bf16_f32 v118, v73, v75
    v_cvt_pk_bf16_f32 v115, v76, v78
    v_cvt_pk_bf16_f32 v119, v77, v79
    s_sub_u32 s52, s52, 1
    s_waitcnt vmcnt(2) lgkmcnt(0)
    v_mfma_f32_32x32x16_bf16 v[32:47], v[128:131], v[176:179], 0
    s_setprio 3
    v_rcp_f32 v48, v48
    v_rcp_f32 v49, v49
    v_rcp_f32 v50, v50
    v_mfma_f32_32x32x16_bf16 v[32:47], v[132:135], v[180:183], v[32:47]
    v_rcp_f32 v51, v51
    v_rcp_f32 v52, v52
    v_rcp_f32 v53, v53
    v_mfma_f32_32x32x16_bf16 v[32:47], v[168:171], v[172:175], v[32:47]
    v_rcp_f32 v54, v54
    v_rcp_f32 v55, v55
    v_rcp_f32 v56, v56
    v_mfma_f32_32x32x16_bf16 v[80:95], v[112:115], v[164:167], v[80:95]
    v_rcp_f32 v57, v57
    v_rcp_f32 v58, v58
    v_rcp_f32 v59, v59
    v_mfma_f32_32x32x16_bf16 v[96:111], v[116:119], v[164:167], v[96:111]
    v_rcp_f32 v60, v60
    v_rcp_f32 v61, v61
    v_rcp_f32 v62, v62
    v_rcp_f32 v63, v63
    s_cbranch_scc1 L_evt0
L_s1:
    s_setprio 0
    s_add_u32 s60, s54, 8
    s_min_u32 s60, s60, s51
    s_sub_u32 s60, s60, s53
    s_cmp_ge_u32 s60, 32
    s_cbranch_scc1 L_flush_mid
L_flret_mid:
    buffer_load_dwordx4 v[128:131], v[186:187], s[28:31], 0 idxen offen
    buffer_load_dwordx4 v[132:135], v[186:187], s[28:31], 0 idxen offen offset:64
    ds_read_u16 v186, v188 offset:512
    ds_read_b128 v[168:171], v190 offset:512
    ds_read_b64_tr_b16 v[160:161], v191 offset:2048
    ds_read_b64_tr_b16 v[162:163], v192 offset:2048
    ds_read_u16_d16_hi v206, v214 offset:62592
    ds_read_u16_d16_hi v207, v214 offset:62594
    ds_read_u16_d16_hi v208, v214 offset:62596
    ds_read2st64_b32 v[210:211], v200 offset0:11 offset1:12
    ds_read2st64_b32 v[212:213], v200 offset0:13 offset1:14
    v_exp_f32 v64, v32
    v_exp_f32 v65, v33
    v_readlane_b32 s54, v200, 0
    s_setprio 1
    v_exp_f32 v66, v34
    v_exp_f32 v67, v35
    s_and_b32 s60, s54, -8
    s_mul_i32 s56, s60, -4
    s_lshr_b32 s60, s60, 1
    v_exp_f32 v68, v36
    v_lshl_add_u32 v215, v200, 2, s56
    v_exp_f32 v69, v37
    v_add_u32 v197, s60, v196
    v_exp_f32 v70, v38
    v_lshlrev_b64 v[202:203], v215, s[48:49]
    v_exp_f32 v71, v39
    v_exp_f32 v72, v40
    v_exp_f32 v73, v41
    v_exp_f32 v74, v42
    v_exp_f32 v75, v43
    v_exp_f32 v76, v44
    v_exp_f32 v77, v45
    v_exp_f32 v78, v46
    v_exp_f32 v79, v47
    s_setprio 2
    v_pk_mul_f32 v[48:49], v[48:49], v[16:17]
    v_pk_mul_f32 v[50:51], v[50:51], v[18:19]
    v_pk_mul_f32 v[52:53], v[52:53], v[20:21]
    v_pk_mul_f32 v[54:55], v[54:55], v[22:23]
    v_pk_mul_f32 v[56:57], v[56:57], v[24:25]
    v_pk_mul_f32 v[58:59], v[58:59], v[26:27]
    v_pk_mul_f32 v[60:61], v[60:61], v[28:29]
    v_pk_mul_f32 v[62:63], v[62:63], v[30:31]
    v_mfma_f32_32x32x8_bf16 v[64:79], v[184:185], v[184:185], v[64:79]
    v_cvt_pk_bf16_f32 v112, v48, v50
    v_cvt_pk_bf16_f32 v116, v49, v51
    v_cvt_pk_bf16_f32 v113, v52, v54
    v_cvt_pk_bf16_f32 v117, v53, v55
    v_cvt_pk_bf16_f32 v114, v56, v58
    v_cvt_pk_bf16_f32 v118, v57, v59
    v_cvt_pk_bf16_f32 v115, v60, v62
    v_cvt_pk_bf16_f32 v119, v61, v63
    s_sub_u32 s52, s52, 1
    s_waitcnt vmcnt(2) lgkmcnt(0)
    v_mfma_f32_32x32x16_bf16 v[16:31], v[120:123], v[176:179], 0
    s_setprio 3
    v_rcp_f32 v64, v64
    v_rcp_f32 v65, v65
    v_rcp_f32 v66, v66
    v_mfma_f32_32x32x16_bf16 v[16:31], v[124:127], v[180:183], v[16:31]
    v_rcp_f32 v67, v67
    v_rcp_f32 v68, v68
    v_rcp_f32 v69, v69
    v_mfma_f32_32x32x16_bf16 v[16:31], v[168:171], v[172:175], v[16:31]
    v_rcp_f32 v70, v70
    v_rcp_f32 v71, v71
    v_rcp_f32 v72, v72
    v_mfma_f32_32x32x16_bf16 v[80:95], v[112:115], v[152:155], v[80:95]
    v_rcp_f32 v73, v73
    v_rcp_f32 v74, v74
    v_rcp_f32 v75, v75
    v_mfma_f32_32x32x16_bf16 v[96:111], v[116:119], v[152:155], v[96:111]
    v_rcp_f32 v76, v76
    v_rcp_f32 v77, v77
    v_rcp_f32 v78, v78
    v_rcp_f32 v79, v79
    s_cbranch_scc1 L_evt1
L_s2:
    s_setprio 0
    buffer_load_dwordx4 v[120:123], v[186:187], s[28:31], 0 idxen offen
    buffer_load_dwordx4 v[124:127], v[186:187], s[28:31], 0 idxen offen offset:64
    ds_read_u16 v186, v188 offset:640
    ds_read_b128 v[168:171], v190 offset:768
    ds_read_b64_tr_b16 v[164:165], v191 offset:3072
    ds_read_b64_tr_b16 v[166:167], v192 offset:3072
    ds_write_b64 v195, v[216:217]
    v_exp_f32 v48, v16
    v_exp_f32 v49, v17
    v_sub_f32 v212, v212, v208
    s_setprio 1
    v_exp_f32 v50, v18
    v_cvt_pk_bf16_f32 v205, v212, 1.0
    v_exp_f32 v51, v19
    v_lshlrev_b32 v215, 16, v205
    v_exp_f32 v52, v20
    v_mul_f32 v214, v215, v215
    v_exp_f32 v53, v21
    v_pk_add_f32 v[210:211], v[210:211], v[206:207] neg_lo:[0,1] neg_hi:[0,1]
    v_exp_f32 v54, v22
    v_cvt_pk_bf16_f32 v204, v210, v211
    v_exp_f32 v55, v23
    v_dot2_f32_bf16 v214, v204, v204, v214
    v_exp_f32 v56, v24
    v_bitop3_b32 v195, v213, 56, v194 bitop3:0x6a
    v_exp_f32 v57, v25
    v_exp_f32 v58, v26
    v_exp_f32 v59, v27
    v_cvt_pk_bf16_f32 v200, v214, v214
    v_exp_f32 v60, v28
    v_exp_f32 v61, v29
    v_exp_f32 v62, v30
    v_exp_f32 v63, v31
    s_setprio 2
    v_pk_mul_f32 v[64:65], v[64:65], v[32:33]
    v_pk_mul_f32 v[66:67], v[66:67], v[34:35]
    v_pk_mul_f32 v[68:69], v[68:69], v[36:37]
    v_pk_mul_f32 v[70:71], v[70:71], v[38:39]
    v_pk_mul_f32 v[72:73], v[72:73], v[40:41]
    v_pk_mul_f32 v[74:75], v[74:75], v[42:43]
    v_pk_mul_f32 v[76:77], v[76:77], v[44:45]
    v_pk_mul_f32 v[78:79], v[78:79], v[46:47]
    v_mfma_f32_32x32x8_bf16 v[48:63], v[184:185], v[184:185], v[48:63]
    v_cvt_pk_bf16_f32 v112, v64, v66
    v_cvt_pk_bf16_f32 v116, v65, v67
    v_cvt_pk_bf16_f32 v113, v68, v70
    v_cvt_pk_bf16_f32 v117, v69, v71
    v_cvt_pk_bf16_f32 v114, v72, v74
    v_cvt_pk_bf16_f32 v118, v73, v75
    v_cvt_pk_bf16_f32 v115, v76, v78
    v_cvt_pk_bf16_f32 v119, v77, v79
    s_sub_u32 s52, s52, 1
    s_waitcnt vmcnt(2) lgkmcnt(0)
    v_mfma_f32_32x32x16_bf16 v[32:47], v[128:131], v[176:179], 0
    s_setprio 3
    v_rcp_f32 v48, v48
    v_rcp_f32 v49, v49
    v_rcp_f32 v50, v50
    v_mfma_f32_32x32x16_bf16 v[32:47], v[132:135], v[180:183], v[32:47]
    v_rcp_f32 v51, v51
    v_rcp_f32 v52, v52
    v_rcp_f32 v53, v53
    v_mfma_f32_32x32x16_bf16 v[32:47], v[168:171], v[172:175], v[32:47]
    v_rcp_f32 v54, v54
    v_rcp_f32 v55, v55
    v_rcp_f32 v56, v56
    v_mfma_f32_32x32x16_bf16 v[80:95], v[112:115], v[156:159], v[80:95]
    v_rcp_f32 v57, v57
    v_rcp_f32 v58, v58
    v_rcp_f32 v59, v59
    v_mfma_f32_32x32x16_bf16 v[96:111], v[116:119], v[156:159], v[96:111]
    v_rcp_f32 v60, v60
    v_rcp_f32 v61, v61
    v_rcp_f32 v62, v62
    v_rcp_f32 v63, v63
    s_cbranch_scc1 L_evt2
L_s3:
    s_setprio 0
    buffer_load_dwordx4 v[128:131], v[186:187], s[28:31], 0 idxen offen
    buffer_load_dwordx4 v[132:135], v[186:187], s[28:31], 0 idxen offen offset:64
    ds_read_u16 v186, v188 offset:768
    ds_write_b128 v193, v[200:203]
    ds_write_b64 v195, v[204:205]
    ds_read2_b32 v[174:175], v197 offset1:1
    ds_read_b128 v[168:171], v190 offset:0
    ds_read_b64_tr_b16 v[152:153], v191 offset:0
    ds_read_b64_tr_b16 v[154:155], v192 offset:0
    ds_read_b64 v[200:201], v189 offset:1024
    v_exp_f32 v64, v32
    v_exp_f32 v65, v33
    v_add_u32 v188, 512, v188
    s_setprio 1
    v_exp_f32 v66, v34
    v_add_u32 v189, 512, v189
    v_exp_f32 v67, v35
    v_exp_f32 v68, v36
    v_exp_f32 v69, v37
    v_exp_f32 v70, v38
    v_exp_f32_e64 v71, v39
    v_exp_f32 v72, v40
    v_exp_f32_e64 v73, v41
    v_exp_f32 v74, v42
    v_exp_f32_e64 v75, v43
    v_exp_f32 v76, v44
    v_exp_f32_e64 v77, v45
    v_exp_f32 v78, v46
    v_exp_f32_e64 v79, v47
    s_setprio 2
    v_pk_mul_f32 v[48:49], v[48:49], v[16:17]
    v_pk_mul_f32 v[50:51], v[50:51], v[18:19]
    v_pk_mul_f32 v[52:53], v[52:53], v[20:21]
    v_pk_mul_f32 v[54:55], v[54:55], v[22:23]
    v_pk_mul_f32 v[56:57], v[56:57], v[24:25]
    v_pk_mul_f32 v[58:59], v[58:59], v[26:27]
    v_pk_mul_f32 v[60:61], v[60:61], v[28:29]
    v_pk_mul_f32 v[62:63], v[62:63], v[30:31]
    v_mfma_f32_32x32x8_bf16 v[64:79], v[184:185], v[184:185], v[64:79]
    v_cvt_pk_bf16_f32 v112, v48, v50
    v_cvt_pk_bf16_f32 v116, v49, v51
    v_cvt_pk_bf16_f32 v113, v52, v54
    v_cvt_pk_bf16_f32 v117, v53, v55
    v_cvt_pk_bf16_f32 v114, v56, v58
    v_cvt_pk_bf16_f32 v118, v57, v59
    v_cvt_pk_bf16_f32 v115, v60, v62
    v_cvt_pk_bf16_f32 v119, v61, v63
    s_sub_u32 s52, s52, 1
    s_waitcnt vmcnt(2) lgkmcnt(0)
    v_mfma_f32_32x32x16_bf16 v[16:31], v[120:123], v[176:179], 0
    s_setprio 3
    v_rcp_f32 v64, v64
    v_rcp_f32 v65, v65
    v_rcp_f32 v66, v66
    v_mfma_f32_32x32x16_bf16 v[16:31], v[124:127], v[180:183], v[16:31]
    v_rcp_f32 v67, v67
    v_rcp_f32 v68, v68
    v_rcp_f32 v69, v69
    v_mfma_f32_32x32x16_bf16 v[16:31], v[168:171], v[172:175], v[16:31]
    v_rcp_f32 v70, v70
    v_rcp_f32 v71, v71
    v_rcp_f32 v72, v72
    v_mfma_f32_32x32x16_bf16 v[80:95], v[112:115], v[160:163], v[80:95]
    v_rcp_f32 v73, v73
    v_rcp_f32 v74, v74
    v_rcp_f32 v75, v75
    v_mfma_f32_32x32x16_bf16 v[96:111], v[116:119], v[160:163], v[96:111]
    v_rcp_f32 v76, v76
    v_rcp_f32 v77, v77
    v_rcp_f32 v78, v78
    v_rcp_f32 v79, v79
    s_cbranch_scc1 L_evt3
    s_branch L_s0
L_evt0:
    s_cmp_eq_u32 s30, 0
    s_mov_b32 s30, 0
    s_mov_b32 s52, 1
    s_cbranch_scc0 L_s1
    s_add_u32 s60, s54, 8
    s_min_u32 s60, s60, s51
    s_sub_u32 s60, s60, s53
    s_cmp_ge_u32 s60, 32
    s_cbranch_scc1 L_flush_dr
L_flret_dr:
    v_pk_mul_f32 v[48:49], v[48:49], v[16:17]
    v_pk_mul_f32 v[50:51], v[50:51], v[18:19]
    v_pk_mul_f32 v[52:53], v[52:53], v[20:21]
    v_pk_mul_f32 v[54:55], v[54:55], v[22:23]
    v_pk_mul_f32 v[56:57], v[56:57], v[24:25]
    v_pk_mul_f32 v[58:59], v[58:59], v[26:27]
    v_pk_mul_f32 v[60:61], v[60:61], v[28:29]
    v_pk_mul_f32 v[62:63], v[62:63], v[30:31]
    s_waitcnt vmcnt(0)
    ds_read_b128 v[120:123], v225 offset:3904
    ds_read_b128 v[124:127], v225 offset:3920
    ds_read_b128 v[128:131], v225 offset:3936
    ds_read_b128 v[132:135], v225 offset:3952
    v_cvt_pk_bf16_f32 v112, v48, v50
    v_cvt_pk_bf16_f32 v116, v49, v51
    v_cvt_pk_bf16_f32 v113, v52, v54
    v_cvt_pk_bf16_f32 v117, v53, v55
    v_cvt_pk_bf16_f32 v114, v56, v58
    v_cvt_pk_bf16_f32 v118, v57, v59
    v_cvt_pk_bf16_f32 v115, v60, v62
    v_cvt_pk_bf16_f32 v119, v61, v63
    s_cmp_lg_u32 s16, 0
    s_nop 0
    v_mfma_f32_32x32x16_bf16 v[80:95], v[112:115], v[152:155], v[80:95]
    v_mfma_f32_32x32x16_bf16 v[96:111], v[116:119], v[152:155], v[96:111]
    s_branch L_final_flush
L_evt1:
    s_cmp_eq_u32 s30, 0
    s_mov_b32 s30, 0
    s_mov_b32 s52, 1
    s_cbranch_scc0 L_s2
    v_pk_mul_f32 v[64:65], v[64:65], v[32:33]
    v_pk_mul_f32 v[66:67], v[66:67], v[34:35]
    v_pk_mul_f32 v[68:69], v[68:69], v[36:37]
    v_pk_mul_f32 v[70:71], v[70:71], v[38:39]
    v_pk_mul_f32 v[72:73], v[72:73], v[40:41]
    v_pk_mul_f32 v[74:75], v[74:75], v[42:43]
    v_pk_mul_f32 v[76:77], v[76:77], v[44:45]
    v_pk_mul_f32 v[78:79], v[78:79], v[46:47]
    s_waitcnt vmcnt(0)
    ds_read_b128 v[120:123], v225 offset:3904
    ds_read_b128 v[124:127], v225 offset:3920
    ds_read_b128 v[128:131], v225 offset:3936
    ds_read_b128 v[132:135], v225 offset:3952
    v_cvt_pk_bf16_f32 v112, v64, v66
    v_cvt_pk_bf16_f32 v116, v65, v67
    v_cvt_pk_bf16_f32 v113, v68, v70
    v_cvt_pk_bf16_f32 v117, v69, v71
    v_cvt_pk_bf16_f32 v114, v72, v74
    v_cvt_pk_bf16_f32 v118, v73, v75
    v_cvt_pk_bf16_f32 v115, v76, v78
    v_cvt_pk_bf16_f32 v119, v77, v79
    s_cmp_lg_u32 s16, 0
    s_nop 0
    v_mfma_f32_32x32x16_bf16 v[80:95], v[112:115], v[156:159], v[80:95]
    v_mfma_f32_32x32x16_bf16 v[96:111], v[116:119], v[156:159], v[96:111]
    s_branch L_final_flush
L_evt2:
    s_cmp_eq_u32 s30, 0
    s_mov_b32 s30, 0
    s_mov_b32 s52, 1
    s_cbranch_scc0 L_s3
    v_pk_mul_f32 v[48:49], v[48:49], v[16:17]
    v_pk_mul_f32 v[50:51], v[50:51], v[18:19]
    v_pk_mul_f32 v[52:53], v[52:53], v[20:21]
    v_pk_mul_f32 v[54:55], v[54:55], v[22:23]
    v_pk_mul_f32 v[56:57], v[56:57], v[24:25]
    v_pk_mul_f32 v[58:59], v[58:59], v[26:27]
    v_pk_mul_f32 v[60:61], v[60:61], v[28:29]
    v_pk_mul_f32 v[62:63], v[62:63], v[30:31]
    s_waitcnt vmcnt(0)
    ds_read_b128 v[120:123], v225 offset:3904
    ds_read_b128 v[124:127], v225 offset:3920
    ds_read_b128 v[128:131], v225 offset:3936
    ds_read_b128 v[132:135], v225 offset:3952
    v_cvt_pk_bf16_f32 v112, v48, v50
    v_cvt_pk_bf16_f32 v116, v49, v51
    v_cvt_pk_bf16_f32 v113, v52, v54
    v_cvt_pk_bf16_f32 v117, v53, v55
    v_cvt_pk_bf16_f32 v114, v56, v58
    v_cvt_pk_bf16_f32 v118, v57, v59
    v_cvt_pk_bf16_f32 v115, v60, v62
    v_cvt_pk_bf16_f32 v119, v61, v63
    s_cmp_lg_u32 s16, 0
    s_nop 0
    v_mfma_f32_32x32x16_bf16 v[80:95], v[112:115], v[160:163], v[80:95]
    v_mfma_f32_32x32x16_bf16 v[96:111], v[116:119], v[160:163], v[96:111]
    s_branch L_final_flush
L_evt3:
    s_cmp_eq_u32 s30, 0
    s_mov_b32 s30, 0
    s_mov_b32 s52, 1
    s_cbranch_scc0 L_s0
    v_pk_mul_f32 v[64:65], v[64:65], v[32:33]
    v_pk_mul_f32 v[66:67], v[66:67], v[34:35]
    v_pk_mul_f32 v[68:69], v[68:69], v[36:37]
    v_pk_mul_f32 v[70:71], v[70:71], v[38:39]
    v_pk_mul_f32 v[72:73], v[72:73], v[40:41]
    v_pk_mul_f32 v[74:75], v[74:75], v[42:43]
    v_pk_mul_f32 v[76:77], v[76:77], v[44:45]
    v_pk_mul_f32 v[78:79], v[78:79], v[46:47]
    s_waitcnt vmcnt(0)
    ds_read_b128 v[120:123], v225 offset:3904
    ds_read_b128 v[124:127], v225 offset:3920
    ds_read_b128 v[128:131], v225 offset:3936
    ds_read_b128 v[132:135], v225 offset:3952
    v_cvt_pk_bf16_f32 v112, v64, v66
    v_cvt_pk_bf16_f32 v116, v65, v67
    v_cvt_pk_bf16_f32 v113, v68, v70
    v_cvt_pk_bf16_f32 v117, v69, v71
    v_cvt_pk_bf16_f32 v114, v72, v74
    v_cvt_pk_bf16_f32 v118, v73, v75
    v_cvt_pk_bf16_f32 v115, v76, v78
    v_cvt_pk_bf16_f32 v119, v77, v79
    s_cmp_lg_u32 s16, 0
    s_nop 0
    v_mfma_f32_32x32x16_bf16 v[80:95], v[112:115], v[164:167], v[80:95]
    v_mfma_f32_32x32x16_bf16 v[96:111], v[116:119], v[164:167], v[96:111]
L_final_flush:
    s_cbranch_scc1 L_slow_final
    v_lshlrev_b32 v56, 16, v234
    v_and_b32 v57, 0xffff0000, v234
    v_lshlrev_b32 v58, 16, v235
    v_and_b32 v59, 0xffff0000, v235
    v_lshlrev_b32 v60, 16, v236
    v_and_b32 v61, 0xffff0000, v236
    v_lshlrev_b32 v62, 16, v237
    v_and_b32 v63, 0xffff0000, v237
    s_nop 1
    v_cvt_pk_bf16_f32 v16, v80, v81
    v_cvt_pk_bf16_f32 v17, v82, v83
    v_cvt_pk_bf16_f32 v18, v84, v85
    v_cvt_pk_bf16_f32 v19, v86, v87
    s_waitcnt lgkmcnt(0)
    ds_write_b128 v198, v[16:19] offset:0
    v_pk_mul_f32 v[4:5], v[80:81], v[136:137]
    v_pk_mul_f32 v[6:7], v[82:83], v[138:139]
    v_pk_fma_f32 v[4:5], v[84:85], v[140:141], v[4:5]
    v_pk_fma_f32 v[6:7], v[86:87], v[142:143], v[6:7]
    v_cvt_pk_bf16_f32 v20, v88, v89
    v_cvt_pk_bf16_f32 v21, v90, v91
    v_cvt_pk_bf16_f32 v22, v92, v93
    v_cvt_pk_bf16_f32 v23, v94, v95
    ds_write_b128 v198, v[20:23] offset:32
    v_pk_fma_f32 v[4:5], v[88:89], v[144:145], v[4:5]
    v_pk_fma_f32 v[6:7], v[90:91], v[146:147], v[6:7]
    v_pk_fma_f32 v[4:5], v[92:93], v[148:149], v[4:5]
    v_pk_fma_f32 v[6:7], v[94:95], v[150:151], v[6:7]
    v_cvt_pk_bf16_f32 v24, v96, v97
    v_cvt_pk_bf16_f32 v25, v98, v99
    v_cvt_pk_bf16_f32 v26, v100, v101
    v_cvt_pk_bf16_f32 v27, v102, v103
    ds_write_b128 v198, v[24:27] offset:64
    v_pk_fma_f32 v[4:5], v[96:97], v[120:121], v[4:5]
    v_pk_fma_f32 v[6:7], v[98:99], v[122:123], v[6:7]
    v_pk_fma_f32 v[4:5], v[100:101], v[124:125], v[4:5]
    v_pk_fma_f32 v[6:7], v[102:103], v[126:127], v[6:7]
    v_cvt_pk_bf16_f32 v28, v104, v105
    v_cvt_pk_bf16_f32 v29, v106, v107
    v_cvt_pk_bf16_f32 v30, v108, v109
    v_cvt_pk_bf16_f32 v31, v110, v111
    ds_write_b128 v198, v[28:31] offset:96
    v_pk_fma_f32 v[4:5], v[104:105], v[128:129], v[4:5]
    v_pk_fma_f32 v[6:7], v[106:107], v[130:131], v[6:7]
    v_pk_fma_f32 v[4:5], v[108:109], v[132:133], v[4:5]
    v_pk_fma_f32 v[6:7], v[110:111], v[134:135], v[6:7]
    v_pk_add_f32 v[4:5], v[4:5], v[6:7]
    v_add_f32 v4, v4, v5
    ds_write_b32 v199, v4 offset:256
L_b6:
    s_cmp_lg_u32 s57, 0
    v_cmp_ne_u32 vcc, 0, v224
    s_waitcnt lgkmcnt(0)
    s_barrier
    s_cbranch_scc1 L_more
    s_cmp_ge_u32 s26, 6
    s_cbranch_scc1 L_finpos
    ds_read_b128 v[32:35], v219 offset:0
    ds_read_b128 v[36:39], v219 offset:64
    ds_read_b128 v[64:67], v3 offset:0
    ds_read_b128 v[68:71], v3 offset:64
    s_mov_b32 s60, 0xbf317218
    s_cmp_lg_u32 s16, 0
    s_cbranch_scc1 L_fin_slow
L_fin_go:
    s_waitcnt lgkmcnt(3)
    v_mfma_f32_16x16x32_bf16 v[40:43], v[238:241], v[32:35], v[226:229]
    v_mfma_f32_16x16x32_bf16 v[44:47], v[246:249], v[32:35], v[230:233]
    s_waitcnt lgkmcnt(2)
    v_mfma_f32_16x16x32_bf16 v[40:43], v[242:245], v[36:39], v[40:43]
    v_mfma_f32_16x16x32_bf16 v[44:47], v[250:253], v[36:39], v[44:47]
L_finbf:
    s_waitcnt lgkmcnt(1)
    v_mfma_f32_16x16x32_bf16 v[40:43], v[238:241], v[64:67], v[40:43]
    v_mfma_f32_16x16x32_bf16 v[44:47], v[246:249], v[64:67], v[44:47]
    s_waitcnt lgkmcnt(0)
    v_mfma_f32_16x16x32_bf16 v[40:43], v[242:245], v[68:71], v[40:43]
    v_mfma_f32_16x16x32_bf16 v[44:47], v[250:253], v[68:71], v[44:47]
    s_cbranch_vccnz L_finbf_more
    s_nop 5
    v_exp_f32 v48, v40
    v_exp_f32 v49, v41
    v_exp_f32 v50, v42
    v_exp_f32 v51, v43
    v_exp_f32 v52, v44
    v_exp_f32 v53, v45
    v_exp_f32 v54, v46
    v_exp_f32 v55, v47
    v_pk_add_f32 v[48:49], v[48:49], 1.0 op_sel_hi:[1,0]
    v_pk_add_f32 v[50:51], v[50:51], 1.0 op_sel_hi:[1,0]
    v_pk_add_f32 v[52:53], v[52:53], 1.0 op_sel_hi:[1,0]
    v_pk_add_f32 v[54:55], v[54:55], 1.0 op_sel_hi:[1,0]
    v_pk_mul_f32 v[40:41], v[40:41], s[60:61] op_sel_hi:[1,0]
    v_pk_mul_f32 v[42:43], v[42:43], s[60:61] op_sel_hi:[1,0]
    v_pk_mul_f32 v[44:45], v[44:45], s[60:61] op_sel_hi:[1,0]
    v_pk_mul_f32 v[46:47], v[46:47], s[60:61] op_sel_hi:[1,0]
    v_rcp_f32 v48, v48
    v_rcp_f32 v49, v49
    v_rcp_f32 v50, v50
    v_rcp_f32 v51, v51
    v_rcp_f32 v52, v52
    v_rcp_f32 v53, v53
    v_rcp_f32 v54, v54
    v_rcp_f32 v55, v55
    v_pk_fma_f32 v[56:57], v[40:41], v[48:49], v[56:57]
    v_pk_fma_f32 v[58:59], v[42:43], v[50:51], v[58:59]
    v_pk_fma_f32 v[60:61], v[44:45], v[52:53], v[60:61]
    v_pk_fma_f32 v[62:63], v[46:47], v[54:55], v[62:63]
    v_cvt_pk_bf16_f32 v40, v56, v57
    v_cvt_pk_bf16_f32 v41, v58, v59
    v_cvt_pk_bf16_f32 v42, v60, v61
    v_cvt_pk_bf16_f32 v43, v62, v63
    s_mov_b64 exec, s[4:5]
    global_store_dwordx4 v12, v[40:43], s[20:21] sc1
    s_endpgm
L_finpos:
    ds_read_b64 v[16:17], v219
L_posbf:
    ds_read_b64 v[18:19], v3
    s_waitcnt lgkmcnt(0)
    v_add_f32 v16, v16, v18
    v_add_f32 v17, v17, v19
    s_cbranch_vccnz L_posbf_more
    v_add_f32 v16, v16, v17
    v_fmac_f32 v230, 0xbf317218, v16
    v_cvt_pk_bf16_f32 v2, v230, v230
    v_mov_b32 v7, s40
    s_mov_b64 exec, s[4:5]
    global_store_short v12, v2, s[20:21] sc1
    s_cmp_lg_u32 s2, 0
    s_cbranch_scc1 L_noep
    s_mov_b64 exec, 1
    global_store_dword v216, v7, s[24:25] sc1
L_noep:
    s_endpgm
L_flush_mid:
    s_nop 7
    v_lshrrev_b32 v8, 5, v254
    v_lshl_add_u32 v8, v8, 4, v198
    v_mov_b32 v2, 0
    ds_read_b128 v[4:7], v225 offset:3840
    s_waitcnt lgkmcnt(0)
    v_fmac_f32 v2, v80, v4
    v_fmac_f32 v2, v81, v5
    v_fmac_f32 v2, v82, v6
    v_fmac_f32 v2, v83, v7
    ds_read_b128 v[4:7], v225 offset:3856
    s_waitcnt lgkmcnt(0)
    v_fmac_f32 v2, v84, v4
    v_fmac_f32 v2, v85, v5
    v_fmac_f32 v2, v86, v6
    v_fmac_f32 v2, v87, v7
    ds_read_b128 v[4:7], v225 offset:3872
    s_waitcnt lgkmcnt(0)
    v_fmac_f32 v2, v88, v4
    v_fmac_f32 v2, v89, v5
    v_fmac_f32 v2, v90, v6
    v_fmac_f32 v2, v91, v7
    ds_read_b128 v[4:7], v225 offset:3888
    s_waitcnt lgkmcnt(0)
    v_fmac_f32 v2, v92, v4
    v_fmac_f32 v2, v93, v5
    v_fmac_f32 v2, v94, v6
    v_fmac_f32 v2, v95, v7
    ds_read_b128 v[4:7], v225 offset:3904
    s_waitcnt lgkmcnt(0)
    v_fmac_f32 v2, v96, v4
    v_fmac_f32 v2, v97, v5
    v_fmac_f32 v2, v98, v6
    v_fmac_f32 v2, v99, v7
    ds_read_b128 v[4:7], v225 offset:3920
    s_waitcnt lgkmcnt(0)
    v_fmac_f32 v2, v100, v4
    v_fmac_f32 v2, v101, v5
    v_fmac_f32 v2, v102, v6
    v_fmac_f32 v2, v103, v7
    ds_read_b128 v[4:7], v225 offset:3936
    s_waitcnt lgkmcnt(0)
    v_fmac_f32 v2, v104, v4
    v_fmac_f32 v2, v105, v5
    v_fmac_f32 v2, v106, v6
    v_fmac_f32 v2, v107, v7
    ds_read_b128 v[4:7], v225 offset:3952
    s_waitcnt lgkmcnt(0)
    v_fmac_f32 v2, v108, v4
    v_fmac_f32 v2, v109, v5
    v_fmac_f32 v2, v110, v6
    v_fmac_f32 v2, v111, v7
    s_mov_b32 exec_lo, 0x88888888
    s_mov_b32 exec_hi, 0x88888888
    ds_add_f32 v8, v80 offset:0
    ds_add_f32 v8, v81 offset:4
    ds_add_f32 v8, v82 offset:8
    ds_add_f32 v8, v83 offset:12
    ds_add_f32 v8, v84 offset:16
    ds_add_f32 v8, v85 offset:20
    ds_add_f32 v8, v86 offset:24
    ds_add_f32 v8, v87 offset:28
    ds_add_f32 v8, v88 offset:64
    ds_add_f32 v8, v89 offset:68
    ds_add_f32 v8, v90 offset:72
    ds_add_f32 v8, v91 offset:76
    ds_add_f32 v8, v92 offset:80
    ds_add_f32 v8, v93 offset:84
    ds_add_f32 v8, v94 offset:88
    ds_add_f32 v8, v95 offset:92
    ds_add_f32 v8, v96 offset:128
    ds_add_f32 v8, v97 offset:132
    ds_add_f32 v8, v98 offset:136
    ds_add_f32 v8, v99 offset:140
    ds_add_f32 v8, v100 offset:144
    ds_add_f32 v8, v101 offset:148
    ds_add_f32 v8, v102 offset:152
    ds_add_f32 v8, v103 offset:156
    ds_add_f32 v8, v104 offset:192
    ds_add_f32 v8, v105 offset:196
    ds_add_f32 v8, v106 offset:200
    ds_add_f32 v8, v107 offset:204
    ds_add_f32 v8, v108 offset:208
    ds_add_f32 v8, v109 offset:212
    ds_add_f32 v8, v110 offset:216
    ds_add_f32 v8, v111 offset:220
    s_mov_b64 exec, -1
    ds_add_f32 v199, v2 offset:256
    s_waitcnt lgkmcnt(0)
    v_mov_b32 v80, 0
    v_mov_b32 v81, 0
    v_mov_b32 v82, 0
    v_mov_b32 v83, 0
    v_mov_b32 v84, 0
    v_mov_b32 v85, 0
    v_mov_b32 v86, 0
    v_mov_b32 v87, 0
    v_mov_b32 v88, 0
    v_mov_b32 v89, 0
    v_mov_b32 v90, 0
    v_mov_b32 v91, 0
    v_mov_b32 v92, 0
    v_mov_b32 v93, 0
    v_mov_b32 v94, 0
    v_mov_b32 v95, 0
    v_mov_b32 v96, 0
    v_mov_b32 v97, 0
    v_mov_b32 v98, 0
    v_mov_b32 v99, 0
    v_mov_b32 v100, 0
    v_mov_b32 v101, 0
    v_mov_b32 v102, 0
    v_mov_b32 v103, 0
    v_mov_b32 v104, 0
    v_mov_b32 v105, 0
    v_mov_b32 v106, 0
    v_mov_b32 v107, 0
    v_mov_b32 v108, 0
    v_mov_b32 v109, 0
    v_mov_b32 v110, 0
    v_mov_b32 v111, 0
    s_mov_b32 s53, s54
    v_subrev_u32 v4, s53, v254
    v_and_b32 v4, 28, v4
    v_add_u32 v4, s53, v4
    v_cmp_eq_u32 vcc, s50, v4
    v_cmp_lt_u32 s[62:63], s51, v4
    s_lshl_b32 s61, s26, 2
    s_add_u32 s61, s61, 160
    v_mov_b32 v7, s61
    v_cndmask_b32 v4, v4, v7, vcc
    v_mov_b32 v7, 16384
    v_cndmask_b32 v4, v4, v7, s[62:63]
    v_mul_u32_u24 v4, 76, v4
    v_add_u32 v4, 40960, v4
    v_lshrrev_b32 v7, 5, v254
    v_lshl_add_u32 v198, v7, 4, v4
    v_lshl_add_u32 v4, v7, 2, v4
    v_and_b32 v7, 3, v254
    v_lshl_add_u32 v199, v7, 3, v4
    v_xor_b32 v7, 3, v7
    v_lshl_add_u32 v198, v7, 20, v198
    s_branch L_flret_mid
L_flush_dr:
    s_nop 7
    v_lshrrev_b32 v8, 5, v254
    v_lshl_add_u32 v8, v8, 4, v198
    v_mov_b32 v2, 0
    ds_read_b128 v[4:7], v225 offset:3840
    s_waitcnt lgkmcnt(0)
    v_fmac_f32 v2, v80, v4
    v_fmac_f32 v2, v81, v5
    v_fmac_f32 v2, v82, v6
    v_fmac_f32 v2, v83, v7
    ds_read_b128 v[4:7], v225 offset:3856
    s_waitcnt lgkmcnt(0)
    v_fmac_f32 v2, v84, v4
    v_fmac_f32 v2, v85, v5
    v_fmac_f32 v2, v86, v6
    v_fmac_f32 v2, v87, v7
    ds_read_b128 v[4:7], v225 offset:3872
    s_waitcnt lgkmcnt(0)
    v_fmac_f32 v2, v88, v4
    v_fmac_f32 v2, v89, v5
    v_fmac_f32 v2, v90, v6
    v_fmac_f32 v2, v91, v7
    ds_read_b128 v[4:7], v225 offset:3888
    s_waitcnt lgkmcnt(0)
    v_fmac_f32 v2, v92, v4
    v_fmac_f32 v2, v93, v5
    v_fmac_f32 v2, v94, v6
    v_fmac_f32 v2, v95, v7
    ds_read_b128 v[4:7], v225 offset:3904
    s_waitcnt lgkmcnt(0)
    v_fmac_f32 v2, v96, v4
    v_fmac_f32 v2, v97, v5
    v_fmac_f32 v2, v98, v6
    v_fmac_f32 v2, v99, v7
    ds_read_b128 v[4:7], v225 offset:3920
    s_waitcnt lgkmcnt(0)
    v_fmac_f32 v2, v100, v4
    v_fmac_f32 v2, v101, v5
    v_fmac_f32 v2, v102, v6
    v_fmac_f32 v2, v103, v7
    ds_read_b128 v[4:7], v225 offset:3936
    s_waitcnt lgkmcnt(0)
    v_fmac_f32 v2, v104, v4
    v_fmac_f32 v2, v105, v5
    v_fmac_f32 v2, v106, v6
    v_fmac_f32 v2, v107, v7
    ds_read_b128 v[4:7], v225 offset:3952
    s_waitcnt lgkmcnt(0)
    v_fmac_f32 v2, v108, v4
    v_fmac_f32 v2, v109, v5
    v_fmac_f32 v2, v110, v6
    v_fmac_f32 v2, v111, v7
    s_mov_b32 exec_lo, 0x88888888
    s_mov_b32 exec_hi, 0x88888888
    ds_add_f32 v8, v80 offset:0
    ds_add_f32 v8, v81 offset:4
    ds_add_f32 v8, v82 offset:8
    ds_add_f32 v8, v83 offset:12
    ds_add_f32 v8, v84 offset:16
    ds_add_f32 v8, v85 offset:20
    ds_add_f32 v8, v86 offset:24
    ds_add_f32 v8, v87 offset:28
    ds_add_f32 v8, v88 offset:64
    ds_add_f32 v8, v89 offset:68
    ds_add_f32 v8, v90 offset:72
    ds_add_f32 v8, v91 offset:76
    ds_add_f32 v8, v92 offset:80
    ds_add_f32 v8, v93 offset:84
    ds_add_f32 v8, v94 offset:88
    ds_add_f32 v8, v95 offset:92
    ds_add_f32 v8, v96 offset:128
    ds_add_f32 v8, v97 offset:132
    ds_add_f32 v8, v98 offset:136
    ds_add_f32 v8, v99 offset:140
    ds_add_f32 v8, v100 offset:144
    ds_add_f32 v8, v101 offset:148
    ds_add_f32 v8, v102 offset:152
    ds_add_f32 v8, v103 offset:156
    ds_add_f32 v8, v104 offset:192
    ds_add_f32 v8, v105 offset:196
    ds_add_f32 v8, v106 offset:200
    ds_add_f32 v8, v107 offset:204
    ds_add_f32 v8, v108 offset:208
    ds_add_f32 v8, v109 offset:212
    ds_add_f32 v8, v110 offset:216
    ds_add_f32 v8, v111 offset:220
    s_mov_b64 exec, -1
    ds_add_f32 v199, v2 offset:256
    s_waitcnt lgkmcnt(0)
    v_mov_b32 v80, 0
    v_mov_b32 v81, 0
    v_mov_b32 v82, 0
    v_mov_b32 v83, 0
    v_mov_b32 v84, 0
    v_mov_b32 v85, 0
    v_mov_b32 v86, 0
    v_mov_b32 v87, 0
    v_mov_b32 v88, 0
    v_mov_b32 v89, 0
    v_mov_b32 v90, 0
    v_mov_b32 v91, 0
    v_mov_b32 v92, 0
    v_mov_b32 v93, 0
    v_mov_b32 v94, 0
    v_mov_b32 v95, 0
    v_mov_b32 v96, 0
    v_mov_b32 v97, 0
    v_mov_b32 v98, 0
    v_mov_b32 v99, 0
    v_mov_b32 v100, 0
    v_mov_b32 v101, 0
    v_mov_b32 v102, 0
    v_mov_b32 v103, 0
    v_mov_b32 v104, 0
    v_mov_b32 v105, 0
    v_mov_b32 v106, 0
    v_mov_b32 v107, 0
    v_mov_b32 v108, 0
    v_mov_b32 v109, 0
    v_mov_b32 v110, 0
    v_mov_b32 v111, 0
    s_mov_b32 s53, s54
    v_subrev_u32 v4, s53, v254
    v_and_b32 v4, 28, v4
    v_add_u32 v4, s53, v4
    v_cmp_eq_u32 vcc, s50, v4
    v_cmp_lt_u32 s[62:63], s51, v4
    s_lshl_b32 s61, s26, 2
    s_add_u32 s61, s61, 160
    v_mov_b32 v7, s61
    v_cndmask_b32 v4, v4, v7, vcc
    v_mov_b32 v7, 16384
    v_cndmask_b32 v4, v4, v7, s[62:63]
    v_mul_u32_u24 v4, 76, v4
    v_add_u32 v4, 40960, v4
    v_lshrrev_b32 v7, 5, v254
    v_lshl_add_u32 v198, v7, 4, v4
    v_lshl_add_u32 v4, v7, 2, v4
    v_and_b32 v7, 3, v254
    v_lshl_add_u32 v199, v7, 3, v4
    v_xor_b32 v7, 3, v7
    v_lshl_add_u32 v198, v7, 20, v198
    s_branch L_flret_dr
L_slow_final:
    s_nop 7
    v_lshrrev_b32 v8, 5, v254
    v_lshl_add_u32 v8, v8, 4, v198
    v_mov_b32 v2, 0
    ds_read_b128 v[4:7], v225 offset:3840
    s_waitcnt lgkmcnt(0)
    v_fmac_f32 v2, v80, v4
    v_fmac_f32 v2, v81, v5
    v_fmac_f32 v2, v82, v6
    v_fmac_f32 v2, v83, v7
    ds_read_b128 v[4:7], v225 offset:3856
    s_waitcnt lgkmcnt(0)
    v_fmac_f32 v2, v84, v4
    v_fmac_f32 v2, v85, v5
    v_fmac_f32 v2, v86, v6
    v_fmac_f32 v2, v87, v7
    ds_read_b128 v[4:7], v225 offset:3872
    s_waitcnt lgkmcnt(0)
    v_fmac_f32 v2, v88, v4
    v_fmac_f32 v2, v89, v5
    v_fmac_f32 v2, v90, v6
    v_fmac_f32 v2, v91, v7
    ds_read_b128 v[4:7], v225 offset:3888
    s_waitcnt lgkmcnt(0)
    v_fmac_f32 v2, v92, v4
    v_fmac_f32 v2, v93, v5
    v_fmac_f32 v2, v94, v6
    v_fmac_f32 v2, v95, v7
    ds_read_b128 v[4:7], v225 offset:3904
    s_waitcnt lgkmcnt(0)
    v_fmac_f32 v2, v96, v4
    v_fmac_f32 v2, v97, v5
    v_fmac_f32 v2, v98, v6
    v_fmac_f32 v2, v99, v7
    ds_read_b128 v[4:7], v225 offset:3920
    s_waitcnt lgkmcnt(0)
    v_fmac_f32 v2, v100, v4
    v_fmac_f32 v2, v101, v5
    v_fmac_f32 v2, v102, v6
    v_fmac_f32 v2, v103, v7
    ds_read_b128 v[4:7], v225 offset:3936
    s_waitcnt lgkmcnt(0)
    v_fmac_f32 v2, v104, v4
    v_fmac_f32 v2, v105, v5
    v_fmac_f32 v2, v106, v6
    v_fmac_f32 v2, v107, v7
    ds_read_b128 v[4:7], v225 offset:3952
    s_waitcnt lgkmcnt(0)
    v_fmac_f32 v2, v108, v4
    v_fmac_f32 v2, v109, v5
    v_fmac_f32 v2, v110, v6
    v_fmac_f32 v2, v111, v7
    s_mov_b32 exec_lo, 0x88888888
    s_mov_b32 exec_hi, 0x88888888
    ds_add_f32 v8, v80 offset:0
    ds_add_f32 v8, v81 offset:4
    ds_add_f32 v8, v82 offset:8
    ds_add_f32 v8, v83 offset:12
    ds_add_f32 v8, v84 offset:16
    ds_add_f32 v8, v85 offset:20
    ds_add_f32 v8, v86 offset:24
    ds_add_f32 v8, v87 offset:28
    ds_add_f32 v8, v88 offset:64
    ds_add_f32 v8, v89 offset:68
    ds_add_f32 v8, v90 offset:72
    ds_add_f32 v8, v91 offset:76
    ds_add_f32 v8, v92 offset:80
    ds_add_f32 v8, v93 offset:84
    ds_add_f32 v8, v94 offset:88
    ds_add_f32 v8, v95 offset:92
    ds_add_f32 v8, v96 offset:128
    ds_add_f32 v8, v97 offset:132
    ds_add_f32 v8, v98 offset:136
    ds_add_f32 v8, v99 offset:140
    ds_add_f32 v8, v100 offset:144
    ds_add_f32 v8, v101 offset:148
    ds_add_f32 v8, v102 offset:152
    ds_add_f32 v8, v103 offset:156
    ds_add_f32 v8, v104 offset:192
    ds_add_f32 v8, v105 offset:196
    ds_add_f32 v8, v106 offset:200
    ds_add_f32 v8, v107 offset:204
    ds_add_f32 v8, v108 offset:208
    ds_add_f32 v8, v109 offset:212
    ds_add_f32 v8, v110 offset:216
    ds_add_f32 v8, v111 offset:220
    s_mov_b64 exec, -1
    ds_add_f32 v199, v2 offset:256
    v_lshlrev_b32 v56, 16, v234
    v_and_b32 v57, 0xffff0000, v234
    v_lshlrev_b32 v58, 16, v235
    v_and_b32 v59, 0xffff0000, v235
    v_lshlrev_b32 v60, 16, v236
    v_and_b32 v61, 0xffff0000, v236
    v_lshlrev_b32 v62, 16, v237
    v_and_b32 v63, 0xffff0000, v237
    s_branch L_b6
L_finbf_more:
    v_ffbl_b32 v5, v224
    v_add_u32 v6, -1, v224
    v_min_u32 v5, 4096, v5
    v_and_b32 v224, v6, v224
    v_mul_u32_u24 v5, 304, v5
    v_add_u32 v3, v209, v5
    ds_read_b128 v[64:67], v3 offset:0
    ds_read_b128 v[68:71], v3 offset:64
    v_cmp_ne_u32 vcc, 0, v224
    s_branch L_finbf
L_fin_slow:
    v_and_b32 v9, 48, v254
    v_add_u32 v9, v9, v219
    ds_read_b128 v[16:19], v9 offset:0
    ds_read_b128 v[20:23], v9 offset:16
    ds_read_b128 v[24:27], v9 offset:128
    ds_read_b128 v[28:31], v9 offset:144
    s_waitcnt lgkmcnt(0)
    v_cvt_pk_bf16_f32 v32, v16, v17
    v_cvt_pk_bf16_f32 v33, v18, v19
    v_cvt_pk_bf16_f32 v34, v20, v21
    v_cvt_pk_bf16_f32 v35, v22, v23
    v_cvt_pk_bf16_f32 v36, v24, v25
    v_cvt_pk_bf16_f32 v37, v26, v27
    v_cvt_pk_bf16_f32 v38, v28, v29
    v_cvt_pk_bf16_f32 v39, v30, v31
    s_branch L_fin_go
L_posbf_more:
    v_ffbl_b32 v5, v224
    v_add_u32 v6, -1, v224
    v_min_u32 v5, 4096, v5
    v_and_b32 v224, v6, v224
    v_mul_u32_u24 v5, 304, v5
    v_add_u32 v3, v209, v5
    v_cmp_ne_u32 vcc, 0, v224
    s_branch L_posbf
L_pollout:
    s_mov_b32 s42, 0
    s_branch L_gotoff
L_stale0:
    s_cmp_eq_u32 s42, 0
    s_cbranch_scc1 L_got0
    s_sub_u32 s42, s42, 1
    v_cmp_lt_i32 vcc, v133, v117
    s_mov_b64 exec, vcc
    global_load_dwordx4 v[16:19], v112, s[8:9] sc1
    s_mov_b64 exec, -1
    s_waitcnt vmcnt(0)
    s_branch L_chk0
L_stale1:
    s_cmp_eq_u32 s42, 0
    s_cbranch_scc1 L_got1
    s_sub_u32 s42, s42, 1
    v_cmp_lt_i32 vcc, v133, v118
    s_mov_b64 exec, vcc
    global_load_dwordx4 v[20:23], v113, s[10:11] sc1
    s_mov_b64 exec, -1
    s_waitcnt vmcnt(0)
    s_branch L_chk1
L_stale2:
    s_cmp_eq_u32 s42, 0
    s_cbranch_scc1 L_got2
    s_sub_u32 s42, s42, 1
    v_cmp_lt_i32 vcc, v133, v119
    s_mov_b64 exec, vcc
    global_load_dwordx4 v[24:27], v114, s[12:13] sc1
    s_mov_b64 exec, -1
    s_waitcnt vmcnt(0)
    s_branch L_chk2
L_stale3:
    s_cmp_eq_u32 s42, 0
    s_cbranch_scc1 L_got3
    s_sub_u32 s42, s42, 1
    v_cmp_lt_i32 vcc, v133, v120
    s_mov_b64 exec, vcc
    global_load_dwordx4 v[28:31], v115, s[14:15] sc1
    s_mov_b64 exec, -1
    s_waitcnt vmcnt(0)
    s_branch L_chk3
L_stale4:
    s_cmp_eq_u32 s42, 0
    s_cbranch_scc1 L_got4
    s_sub_u32 s42, s42, 1
    s_mov_b64 exec, s[94:95]
    global_load_dwordx4 v[32:35], v116, s[8:9] offset:128 sc1
    s_mov_b64 exec, -1
    s_waitcnt vmcnt(0)
    s_branch L_chk4
L_pad0:
    v_mov_b32 v8, v1
    v_mov_b32 v9, 32512
    s_mov_b64 exec, vcc
L_pad:
    v_add_u32 v7, v6, v2
    v_add_u32 v2, 8, v2
    ds_write_b64 v7, v[8:9]
    v_cmp_lt_u32 vcc, v2, v4
    s_and_b64 exec, vcc, vcc
    s_cbranch_scc1 L_pad
    s_mov_b64 exec, -1
    s_branch L_nopad
L_more:
    s_waitcnt vmcnt(0)
    s_setprio 0
    s_mov_b32 s30, 10000
    s_mov_b64 s[6:7], 0
    s_mov_b32 s41, 1
    s_cmp_eq_u32 s43, 48
    s_cselect_b32 s60, 48, 0x100
    v_mov_b32 v4, s60
    v_and_b32 v5, 0xfff0, v220
    v_lshrrev_b32 v6, 16, v220
    v_add_u32 v7, s43, v5
    v_cmp_lt_u32 vcc, v7, v6
    v_add_u32 v5, v4, v5
    v_min_u32 v5, v5, v6
    v_lshl_or_b32 v220, v6, 16, v5
    v_mov_b32 v7, s43
    v_cndmask_b32 v4, v4, v7, vcc
    v_and_b32 v5, 0xfff0, v221
    v_lshrrev_b32 v6, 16, v221
    v_add_u32 v7, s43, v5
    v_cmp_lt_u32 vcc, v7, v6
    v_add_u32 v5, v4, v5
    v_min_u32 v5, v5, v6
    v_lshl_or_b32 v221, v6, 16, v5
    v_mov_b32 v7, s43
    v_cndmask_b32 v4, v4, v7, vcc
    v_and_b32 v5, 0xfff0, v222
    v_lshrrev_b32 v6, 16, v222
    v_add_u32 v7, s43, v5
    v_cmp_lt_u32 vcc, v7, v6
    v_add_u32 v5, v4, v5
    v_min_u32 v5, v5, v6
    v_lshl_or_b32 v222, v6, 16, v5
    v_mov_b32 v7, s43
    v_cndmask_b32 v4, v4, v7, vcc
    v_and_b32 v5, 0xfff0, v223
    v_lshrrev_b32 v6, 16, v223
    v_add_u32 v7, s43, v5
    v_cmp_lt_u32 vcc, v7, v6
    v_add_u32 v5, v4, v5
    v_min_u32 v5, v5, v6
    v_lshl_or_b32 v223, v6, 16, v5
    v_mov_b32 v7, s43
    v_cndmask_b32 v4, v4, v7, vcc
    s_movk_i32 s43, 0x80
    v_lshrrev_b32 v1, 3, v0
    v_and_b32 v2, 7, v0
    v_lshlrev_b32 v133, 4, v2
    v_mul_u32_u24 v1, 13440, v1
    v_add_u32 v132, v1, v133
    v_mov_b32 v116, 0
    v_mov_b64 v[16:17], s[36:37]
    v_mov_b64 v[18:19], s[38:39]
    v_mov_b64 v[20:21], s[36:37]
    v_mov_b64 v[22:23], s[38:39]
    v_mov_b64 v[24:25], s[36:37]
    v_mov_b64 v[26:27], s[38:39]
    v_mov_b64 v[28:29], s[36:37]
    v_mov_b64 v[30:31], s[38:39]
    v_mov_b32 v134, 0
    s_branch L_fetch
L_narrow:
    s_mov_b32 s17, 0
    s_mov_b64 exec, vcc
    ds_write_b32 v216, v13 offset:2300
    s_mov_b64 exec, -1
    s_branch L_nob0
L_redo:
    s_cmp_eq_u32 s43, 48
    s_cbranch_scc1 L_end
    s_waitcnt vmcnt(0) lgkmcnt(0)
    s_barrier
    ds_write_b32 v1, v216 offset:2048
    s_movk_i32 s43, 48
    v_lshrrev_b32 v1, 3, v0
    v_and_b32 v2, 7, v0
    v_lshlrev_b32 v133, 4, v2
    v_mul_u32_u24 v1, 13440, v1
    v_add_u32 v132, v1, v133
    v_mov_b32 v116, 0
    v_mov_b64 v[16:17], s[36:37]
    v_mov_b64 v[18:19], s[38:39]
    v_mov_b64 v[20:21], s[36:37]
    v_mov_b64 v[22:23], s[38:39]
    v_mov_b64 v[24:25], s[36:37]
    v_mov_b64 v[26:27], s[38:39]
    v_mov_b64 v[28:29], s[36:37]
    v_mov_b64 v[30:31], s[38:39]
    v_cmp_gt_u32 vcc, 48, v133
    v_mov_b32 v1, 1048576
    s_waitcnt lgkmcnt(0)
    v_cndmask_b32 v133, v1, v133, vcc
    s_barrier
    s_branch L_fetch
L_end:
    s_endpgm
.section .rodata,"a"
.p2align 6
.amdhsa_kernel standalone__cheap_equivariant_egnn__graph_kernel
  .amdhsa_next_free_vgpr 256
  .amdhsa_next_free_sgpr 102
  .amdhsa_accum_offset 256
  .amdhsa_group_segment_fixed_size 0
  .amdhsa_kernarg_size 88
  .amdhsa_user_sgpr_count 2
  .amdhsa_user_sgpr_kernarg_segment_ptr 1
  .amdhsa_system_sgpr_workgroup_id_x 1
  .amdhsa_float_denorm_mode_32 3
.end_amdhsa_kernel
```
